```python
import torch

def _softmax(x, axis=-1):
    return torch.softmax(x, dim=axis)
def _gelu(x):
    return torch.nn.functional.gelu(x, approximate="tanh")
def _silu(x):
    return torch.nn.functional.silu(x)
def _sigmoid(x):
    return torch.sigmoid(x)
def _layernorm(x, axis=-1, eps=1e-5):
    m = x.mean(dim=axis, keepdim=True)
    v = x.var(dim=axis, keepdim=True, unbiased=False)
    return (x - m) / torch.sqrt(v + eps)
def _scatter_add(tgt, idx, src, axis=0):
    return tgt.clone().index_add_(axis, idx, src)
def _segment_sum(src, seg, n):
    out = torch.zeros((n,) + src.shape[1:], dtype=src.dtype)
    return out.index_add_(0, seg, src)
def _pad(x, pw):
    flat = tuple(v for pair in reversed(pw) for v in pair)
    return torch.nn.functional.pad(x, flat)

kernel_name = 'interleave_layers__sliding_local_dilated__dense_activation_silu__prompt'

def setup_inputs():

    _w = (lambda a: (lambda t: t.to(torch.bfloat16) if t.is_floating_point() else t)(torch.as_tensor(a)))
    def _A_setup():
        B, S, D = 1, 2048, 512
        return {
            "x": _w((lambda *s: torch.randn(*s, dtype=torch.bfloat16) * 0.05)(B, S, D)),
            "wqkv": _w((lambda *s: torch.randn(*s, dtype=torch.bfloat16) * 0.05)(D, 3 * D)),
            "wo": _w((lambda *s: torch.randn(*s, dtype=torch.bfloat16) * 0.05)(D, D)),
        }
    _A_in = _A_setup()

    def _B_setup():
        B, S, D, F = 1, 2048, 512, 1792
        return {
            "x": _w((lambda *s: torch.randn(*s, dtype=torch.bfloat16) * 0.05)(B, S, D)),
            "w1": _w((lambda *s: torch.randn(*s, dtype=torch.bfloat16) * 0.8)(D, F) * (D ** -0.5)),
            "w2": _w((lambda *s: torch.randn(*s, dtype=torch.bfloat16) * 0.8)(F, D) * (F ** -0.5)),
        }
    _B_in = _B_setup()

    return {
        "A_x": _A_in["x"],
        "A_wqkv": _A_in["wqkv"],
        "A_wo": _A_in["wo"],
        "B_x": _B_in["x"],
        "B_w1": _B_in["w1"],
        "B_w2": _B_in["w2"],
    }

def reference(A_x, A_wqkv, A_wo, B_x, B_w1, B_w2):
    def _A_ref(x, wqkv, wo):
        B, S, D = x.shape
        H = 32; Dh = D // H
        W, dil = 8, 2
        qkv = (lambda x, *d: x.permute(*d))((x @ wqkv).reshape(B, S, 3, H, Dh), 2, 0, 3, 1, 4)
        q, k, v = qkv[0], qkv[1], qkv[2]
        scale = Dh ** -0.5
        pos = torch.arange(S)
        off = torch.arange(W) * dil
        idx = pos[:, None] - off[None, :]
        mask = idx >= 0
        idx_c = torch.where(mask, idx, 0).reshape(-1)
        kg = k[:, :, idx_c, :].reshape(B, H, S, W, Dh)
        vg = v[:, :, idx_c, :].reshape(B, H, S, W, Dh)
        logits = torch.einsum("bhsd,bhswd->bhsw", q, kg) * scale
        logits = torch.where(mask[None, None, :, :], logits, -1e9)
        attn = _softmax(logits, axis=-1)
        o = torch.einsum("bhsw,bhswd->bhsd", attn, vg)
        return (lambda x, *d: x.permute(*d))(o, 0, 2, 1, 3).reshape(B, S, D) @ wo

    def _B_ref(x, w1, w2):
        h = torch.einsum("bsd,df->bsf", x, w1)
        h = _silu(h)
        out = torch.einsum("bsf,fd->bsd", h, w2)
        return out

    x = A_x
    x = x + _A_ref(_layernorm(x, axis=-1), A_wqkv, A_wo)
    x = x + _B_ref(_layernorm(x, axis=-1), B_w1, B_w2)
    x = x + _A_ref(_layernorm(x, axis=-1), A_wqkv, A_wo)
    x = x + _B_ref(_layernorm(x, axis=-1), B_w1, B_w2)
    return x
```

```asm
; @launch grid=(256,1,1) block=(256,1,1) lds=163840
.amdgcn_target "amdgcn-amd-amdhsa--gfx950"
.text
.globl interleave_layers__sliding_local_dilated__dense_activation_silu__prompt_kernel
.p2align 8
.type interleave_layers__sliding_local_dilated__dense_activation_silu__prompt_kernel,@function
interleave_layers__sliding_local_dilated__dense_activation_silu__prompt_kernel:
s_cmp_ge_u32 s2, 256
s_cbranch_scc1 Lend
s_mov_b32 s96, s2
s_load_dwordx2 s[4:5], s[0:1], 0
s_load_dwordx2 s[8:9], s[0:1], 8
s_load_dwordx2 s[12:13], s[0:1], 16
s_load_dwordx2 s[16:17], s[0:1], 32
s_load_dwordx2 s[20:21], s[0:1], 40
s_load_dwordx2 s[24:25], s[0:1], 64
s_load_dwordx2 s[28:29], s[0:1], 48
s_load_dwordx2 s[32:33], s[0:1], 56
s_mov_b32 s6, 2097152
s_mov_b32 s7, 0x20000
s_mov_b32 s10, 1572864
s_mov_b32 s11, 0x20000
s_mov_b32 s14, 524288
s_mov_b32 s15, 0x20000
s_mov_b32 s18, 1835008
s_mov_b32 s19, 0x20000
s_mov_b32 s22, 1835008
s_mov_b32 s23, 0x20000
s_mov_b32 s26, 67108864
s_mov_b32 s27, 0x20000
s_mov_b32 s30, 2097152
s_mov_b32 s31, 0x20000
s_mov_b32 s34, 256
s_mov_b32 s35, 0x20000
v_lshrrev_b32 v17, 6, v0
v_and_b32 v0, 63, v0
v_readfirstlane_b32 s38, v17
s_and_b32 s36, s2, 6
s_lshl_b32 s36, s36, 1
s_lshr_b32 s58, s2, 6
s_add_u32 s36, s36, s58
s_bfe_u32 s37, s2, 0x30003
s_and_b32 s57, s2, 1
s_lshl_b32 s58, s57, 3
s_add_u32 s37, s37, s58
s_lshr_b32 s62, s37, 3
s_and_b32 s63, s37, 7
s_lshl_b32 s57, s36, 3
s_lshl_b32 s58, s62, 2
s_add_u32 s58, s58, s57
s_add_u32 s58, s58, s38
s_lshl_b32 s42, s58, 14
s_lshl_b32 s58, s38, 1
s_add_u32 s58, s58, s57
s_lshl_b32 s43, s58, 14
v_lshrrev_b32 v15, 4, v0
v_and_b32 v17, 15, v0
v_lshlrev_b32 v59, 10, v17
v_and_b32 v18, 1, v15
v_lshl_add_u32 v59, v18, 5, v59
v_lshrrev_b32 v18, 1, v15
v_lshl_add_u32 v59, v18, 4, v59
s_lshl_b32 s58, s63, 7
s_add_u32 s52, s42, s58
s_waitcnt lgkmcnt(0)
buffer_load_dwordx4 v[2:5], v59, s[4:7], s52 offen offset:0
buffer_load_dwordx4 v[6:9], v59, s[4:7], s52 offen offset:64
s_or_b32 s57, s2, s38
s_cmp_lg_u32 s57, 0
s_cbranch_scc1 Lnn
s_memrealtime s[44:45]
v_mov_b32 v19, 0
s_waitcnt lgkmcnt(0)
s_lshl_b64 s[44:45], s[44:45], 4
s_or_b32 s45, s45, 0x40000000
v_mov_b32 v20, s44
v_mov_b32 v21, s45
s_mov_b64 exec, 1
buffer_store_dwordx2 v[20:21], v19, s[32:35], 0 offen sc1
s_mov_b64 exec, -1
Lnn:
v_lshrrev_b32 v14, 2, v0
v_mul_u32_u24 v11, 3072, v14
v_and_b32 v17, 1, v15
v_lshlrev_b32 v17, 1, v17
v_xor_b32 v17, v17, v0
v_and_b32 v17, 3, v17
v_lshl_add_u32 v11, v17, 4, v11
s_lshl_b32 s57, s37, 6
v_add_u32 v11, s57, v11
s_mov_b32 s39, 0
s_mov_b64 s[44:45], 0
s_mul_i32 s53, s38, 393216
s_lshl_b32 s54, s38, 13
s_mov_b32 s60, 0
s_mov_b32 s61, 0
s_lshl_b32 s47, s38, 14
s_lshl_b32 s46, s63, 16
s_add_u32 s46, s46, s47
s_add_u32 s46, s46, 48234496
s_mul_i32 s49, s38, 7168
s_mul_i32 s48, s37, 114688
s_add_u32 s48, s48, s49
s_add_u32 s48, s48, 49283072
s_lshl_b32 s50, s63, 2
s_add_u32 s50, s50, s38
s_mul_i32 s50, s50, 57344
s_add_u32 s50, s50, 52428800
s_lshl_b32 s51, s38, 12
s_mul_i32 s55, s37, 98304
s_add_u32 s55, s55, s51
s_add_u32 s55, s55, 46137344
s_add_u32 s57, s38, 0
s_and_b32 s57, s57, 3
s_mul_i32 s56, s57, 57344
s_add_u32 s57, s38, 1
s_and_b32 s57, s57, 3
s_mul_i32 s99, s57, 57344
s_add_u32 s57, s38, 2
s_and_b32 s57, s57, 3
s_mul_i32 s100, s57, 57344
s_add_u32 s57, s38, 3
s_and_b32 s57, s57, 3
s_mul_i32 s101, s57, 57344
s_cmp_eq_u32 s38, 1
s_cbranch_scc1 Lpk1
s_cmp_eq_u32 s38, 2
s_cbranch_scc1 Lpk2
s_cmp_eq_u32 s38, 3
s_cbranch_scc1 Lpk3
s_mul_i32 s57, s36, 98304
s_lshl_b32 s58, s36, 11
s_add_u32 s58, s58, s55
Lpk0a:
s_add_u32 s40, s57, 0
buffer_load_dwordx4 v[64:67], v11, s[8:11], s40 offen
s_add_u32 s40, s57, 49152
buffer_load_dwordx4 v[68:71], v11, s[8:11], s40 offen
s_add_u32 s40, s57, 1024
buffer_load_dwordx4 v[72:75], v11, s[8:11], s40 offen
s_add_u32 s40, s57, 50176
buffer_load_dwordx4 v[76:79], v11, s[8:11], s40 offen
s_add_u32 s40, s57, 2048
buffer_load_dwordx4 v[80:83], v11, s[8:11], s40 offen
s_add_u32 s40, s57, 51200
buffer_load_dwordx4 v[84:87], v11, s[8:11], s40 offen
s_add_u32 s2, s58, 0
s_add_u32 s3, s58, 1024
s_add_u32 s4, s58, 32768
s_add_u32 s5, s58, 33792
s_add_u32 s6, s58, 65536
s_add_u32 s7, s58, 66560
s_mov_b32 s97, 6
s_branch Lpk
Lpk1:
s_mul_i32 s57, s37, 224
v_add_u32 v17, 0, v0
v_mul_u32_u24 v18, 4682, v17
v_lshrrev_b32 v18, 16, v18
v_mul_u32_u24 v52, 3360, v18
v_lshl_add_u32 v52, v17, 4, v52
v_add_u32 v52, s57, v52
v_add_u32 v17, 64, v0
v_mul_u32_u24 v18, 4682, v17
v_lshrrev_b32 v18, 16, v18
v_mul_u32_u24 v53, 3360, v18
v_lshl_add_u32 v53, v17, 4, v53
v_add_u32 v53, s57, v53
v_add_u32 v17, 128, v0
v_mul_u32_u24 v18, 4682, v17
v_lshrrev_b32 v18, 16, v18
v_mul_u32_u24 v54, 3360, v18
v_lshl_add_u32 v54, v17, 4, v54
v_add_u32 v54, s57, v54
v_add_u32 v17, 192, v0
v_mul_u32_u24 v18, 4682, v17
v_lshrrev_b32 v18, 16, v18
v_mul_u32_u24 v55, 3360, v18
v_lshl_add_u32 v55, v17, 4, v55
v_add_u32 v55, s57, v55
v_add_u32 v17, 256, v0
v_mul_u32_u24 v18, 4682, v17
v_lshrrev_b32 v18, 16, v18
v_mul_u32_u24 v56, 3360, v18
v_lshl_add_u32 v56, v17, 4, v56
v_add_u32 v56, s57, v56
v_add_u32 v17, 320, v0
v_mul_u32_u24 v18, 4682, v17
v_lshrrev_b32 v18, 16, v18
v_mul_u32_u24 v57, 3360, v18
v_lshl_add_u32 v57, v17, 4, v57
v_add_u32 v57, s57, v57
v_add_u32 v17, 384, v0
v_mul_u32_u24 v18, 4682, v17
v_lshrrev_b32 v18, 16, v18
v_mul_u32_u24 v58, 3360, v18
v_lshl_add_u32 v58, v17, 4, v58
v_add_u32 v58, s57, v58
s_mul_i32 s40, s36, 114688
s_mul_i32 s58, s36, 7168
s_add_u32 s58, s58, s48
s_sub_u32 s58, s58, s49
s_mov_b32 m0, 131072
s_nop 0
buffer_load_dwordx4 v52, s[16:19], s40 offen lds
s_mov_b32 m0, 132096
s_nop 0
buffer_load_dwordx4 v53, s[16:19], s40 offen lds
s_mov_b32 m0, 133120
s_nop 0
buffer_load_dwordx4 v54, s[16:19], s40 offen lds
s_mov_b32 m0, 134144
s_nop 0
buffer_load_dwordx4 v55, s[16:19], s40 offen lds
s_mov_b32 m0, 135168
s_nop 0
buffer_load_dwordx4 v56, s[16:19], s40 offen lds
s_mov_b32 m0, 136192
s_nop 0
buffer_load_dwordx4 v57, s[16:19], s40 offen lds
s_mov_b32 m0, 137216
s_nop 0
buffer_load_dwordx4 v58, s[16:19], s40 offen lds
Lpk1a:
s_add_u32 s2, s58, 0
s_add_u32 s3, s58, 1024
s_add_u32 s4, s58, 2048
s_add_u32 s5, s58, 3072
s_add_u32 s6, s58, 4096
s_add_u32 s7, s58, 5120
s_add_u32 s98, s58, 6144
s_mov_b32 s97, 7
s_branch Lpk
Lpk2:
v_lshrrev_b32 v10, 3, v0
v_lshlrev_b32 v10, 10, v10
v_lshlrev_b32 v17, 1, v15
v_xor_b32 v17, v17, v0
v_and_b32 v17, 7, v17
v_lshl_add_u32 v10, v17, 4, v10
s_lshl_b32 s57, s63, 7
v_add_u32 v10, s57, v10
s_lshl_b32 s57, s36, 1
s_add_u32 s57, s57, s62
s_mul_i32 s57, s57, 57344
s_lshr_b32 s58, s36, 2
s_sub_u32 s58, s58, 2
s_mul_i32 s58, s58, 57344
s_add_u32 s58, s58, s50
s_and_b32 s41, s36, 3
s_lshl_b32 s59, s41, 11
s_add_u32 s59, s59, 44032
s_add_u32 s59, s59, s58
s_mul_i32 s41, s41, 12288
s_add_u32 s58, s58, s41
s_mul_i32 s41, s62, 7168
s_add_u32 s58, s58, s41
s_cmp_eq_u32 s62, 0
s_cselect_b32 s59, s58, s59
Lpk2a:
s_add_u32 s40, s57, 0
buffer_load_dwordx4 v[64:67], v10, s[20:23], s40 offen
s_add_u32 s40, s57, 8192
buffer_load_dwordx4 v[68:71], v10, s[20:23], s40 offen
s_add_u32 s40, s57, 16384
buffer_load_dwordx4 v[72:75], v10, s[20:23], s40 offen
s_add_u32 s40, s57, 24576
buffer_load_dwordx4 v[76:79], v10, s[20:23], s40 offen
s_add_u32 s40, s57, 32768
buffer_load_dwordx4 v[80:83], v10, s[20:23], s40 offen
s_add_u32 s40, s57, 40960
buffer_load_dwordx4 v[84:87], v10, s[20:23], s40 offen
s_add_u32 s40, s57, 49152
buffer_load_dwordx4 v[88:91], v10, s[20:23], s40 offen
s_add_u32 s2, s58, 0
s_add_u32 s3, s58, 1024
s_add_u32 s4, s58, 2048
s_add_u32 s5, s58, 3072
s_add_u32 s6, s58, 4096
s_add_u32 s7, s59, 5120
s_add_u32 s98, s59, 6144
s_mov_b32 s97, 7
s_branch Lpk
Lpk3:
v_lshrrev_b32 v10, 3, v0
v_lshlrev_b32 v10, 10, v10
v_lshlrev_b32 v17, 1, v15
v_xor_b32 v17, v17, v0
v_and_b32 v17, 7, v17
v_lshl_add_u32 v10, v17, 4, v10
s_lshl_b32 s57, s63, 7
v_add_u32 v10, s57, v10
s_lshl_b32 s57, s36, 1
s_add_u32 s57, s57, s62
s_lshl_b32 s58, s57, 11
s_lshl_b32 s57, s57, 14
s_add_u32 s58, s58, s46
s_sub_u32 s58, s58, s47
Lpk3a:
s_add_u32 s40, s57, 0
buffer_load_dwordx4 v[64:67], v10, s[12:15], s40 offen
s_add_u32 s40, s57, 8192
buffer_load_dwordx4 v[68:71], v10, s[12:15], s40 offen
s_add_u32 s2, s58, 0
s_add_u32 s3, s58, 1024
s_mov_b32 s97, 2
s_branch Lpk
Lpk:
v_lshlrev_b32 v1, 4, v0
v_and_b32 v16, 3, v0
v_lshlrev_b32 v16, 3, v16
v_mov_b32 v28, 0x3f803f80
v_mov_b32 v29, 0x3f803f80
v_mov_b32 v30, 0x3f803f80
v_mov_b32 v31, 0x3f803f80
s_lshl_b32 s57, s36, 8
s_add_u32 s57, s57, 41943040
v_and_b32 v17, 15, v0
v_lshl_add_u32 v12, v17, 3, s57
s_cmp_eq_u32 s36, 0
s_cselect_b32 s58, 0, 256
v_and_b32 v17, 1, v15
v_mul_u32_u24 v17, s58, v17
v_sub_u32 v13, v12, v17
v_and_b32 v17, 15, v0
v_lshlrev_b32 v60, 3, v17
v_lshl_add_u32 v60, v15, 8, v60
s_cmp_lg_u32 s38, 0
s_cbranch_scc1 Lng
v_mov_b32 v19, 0
s_mov_b32 s59, 0x40000
Lnp:
buffer_load_dwordx2 v[20:21], v19, s[32:35], 0 offen sc1
s_sub_u32 s59, s59, 1
s_cbranch_scc1 Lend
s_waitcnt vmcnt(0)
v_readfirstlane_b32 s44, v20
v_readfirstlane_b32 s45, v21
s_nop 1
s_cmp_eq_u32 s45, 0
s_cbranch_scc1 Lnp
Lng:
s_waitcnt vmcnt(0)
v_permlane16_swap_b32 v2, v4
v_permlane16_swap_b32 v3, v5
v_permlane16_swap_b32 v6, v8
v_permlane16_swap_b32 v7, v9
s_cmp_lg_u32 s38, 1
s_cbranch_scc1 Lntr
v_mul_u32_u24 v17, 224, v14
v_add_u32 v17, v17, v16
v_add_u32 v17, 0x20000, v17
ds_read_b64_tr_b16 v[64:65], v17 offset:0
ds_read_b64_tr_b16 v[66:67], v17 offset:3584
ds_read_b64_tr_b16 v[68:69], v17 offset:32
ds_read_b64_tr_b16 v[70:71], v17 offset:3616
ds_read_b64_tr_b16 v[72:73], v17 offset:64
ds_read_b64_tr_b16 v[74:75], v17 offset:3648
ds_read_b64_tr_b16 v[76:77], v17 offset:96
ds_read_b64_tr_b16 v[78:79], v17 offset:3680
ds_read_b64_tr_b16 v[80:81], v17 offset:128
ds_read_b64_tr_b16 v[82:83], v17 offset:3712
ds_read_b64_tr_b16 v[84:85], v17 offset:160
ds_read_b64_tr_b16 v[86:87], v17 offset:3744
ds_read_b64_tr_b16 v[88:89], v17 offset:192
ds_read_b64_tr_b16 v[90:91], v17 offset:3776
Lntr:
v_lshlrev_b32 v96, 16, v2
v_and_b32 v97, 0xffff0000, v2
v_lshlrev_b32 v98, 16, v3
v_and_b32 v99, 0xffff0000, v3
v_lshlrev_b32 v100, 16, v4
v_and_b32 v101, 0xffff0000, v4
v_lshlrev_b32 v102, 16, v5
v_and_b32 v103, 0xffff0000, v5
v_lshlrev_b32 v104, 16, v6
v_and_b32 v105, 0xffff0000, v6
v_lshlrev_b32 v106, 16, v7
v_and_b32 v107, 0xffff0000, v7
v_lshlrev_b32 v108, 16, v8
v_and_b32 v109, 0xffff0000, v8
v_lshlrev_b32 v110, 16, v9
v_and_b32 v111, 0xffff0000, v9
s_lshl_b32 s58, s63, 11
s_add_u32 s58, s58, s42
s_add_u32 s58, s58, s60
s_add_u32 s53, s58, 12582912
buffer_store_dwordx4 v[2:5], v1, s[24:27], s53 offen offset:0 sc1
buffer_store_dwordx4 v[6:9], v1, s[24:27], s53 offen offset:1024 sc1
v_pk_mul_f32 v[20:21], v[96:97], v[96:97]
v_pk_fma_f32 v[20:21], v[98:99], v[98:99], v[20:21]
v_pk_add_f32 v[96:97], v[96:97], v[98:99]
v_pk_fma_f32 v[20:21], v[100:101], v[100:101], v[20:21]
v_pk_add_f32 v[96:97], v[96:97], v[100:101]
v_pk_fma_f32 v[20:21], v[102:103], v[102:103], v[20:21]
v_pk_add_f32 v[96:97], v[96:97], v[102:103]
v_pk_fma_f32 v[20:21], v[104:105], v[104:105], v[20:21]
v_pk_add_f32 v[96:97], v[96:97], v[104:105]
v_pk_fma_f32 v[20:21], v[106:107], v[106:107], v[20:21]
v_pk_add_f32 v[96:97], v[96:97], v[106:107]
v_pk_fma_f32 v[20:21], v[108:109], v[108:109], v[20:21]
v_pk_add_f32 v[96:97], v[96:97], v[108:109]
v_pk_fma_f32 v[20:21], v[110:111], v[110:111], v[20:21]
v_pk_add_f32 v[96:97], v[96:97], v[110:111]
v_add_f32 v21, v20, v21
v_add_f32 v20, v96, v97
v_mov_b32 v17, v20
s_nop 1
v_permlane16_swap_b32 v20, v17
v_add_f32 v20, v20, v17
v_mov_b32 v17, v20
s_nop 1
v_permlane32_swap_b32 v20, v17
v_add_f32 v20, v20, v17
v_mov_b32 v18, v21
s_nop 1
v_permlane16_swap_b32 v21, v18
v_add_f32 v21, v21, v18
v_mov_b32 v18, v21
s_nop 1
v_permlane32_swap_b32 v21, v18
v_add_f32 v21, v21, v18
s_lshr_b32 s58, s42, 4
s_lshl_b32 s57, s63, 7
s_add_u32 s58, s58, s57
s_add_u32 s58, s58, s60
s_add_u32 s54, s58, 14680064
v_lshlrev_b32 v17, 3, v0
s_mov_b64 exec, 0xffff
buffer_store_dwordx2 v[20:21], v17, s[24:27], s54 offen sc1
s_mov_b64 exec, -1
s_waitcnt lgkmcnt(0)
buffer_store_dwordx4 v[64:67], v1, s[24:27], s2 offen sc1
buffer_store_dwordx4 v[68:71], v1, s[24:27], s3 offen sc1
s_cmp_le_u32 s97, 2
s_cbranch_scc1 Lpks
buffer_store_dwordx4 v[72:75], v1, s[24:27], s4 offen sc1
buffer_store_dwordx4 v[76:79], v1, s[24:27], s5 offen sc1
buffer_store_dwordx4 v[80:83], v1, s[24:27], s6 offen sc1
buffer_store_dwordx4 v[84:87], v1, s[24:27], s7 offen sc1
s_cmp_le_u32 s97, 6
s_cbranch_scc1 Lpks
buffer_store_dwordx4 v[88:91], v1, s[24:27], s98 offen sc1
Lpks:
s_and_b32 s83, s37, 3
s_add_u32 s57, s83, 0
s_and_b32 s57, s57, 3
s_lshl_b32 s64, s57, 12
s_mul_i32 s68, s57, 28672
s_add_u32 s68, s68, s48
s_mul_i32 s72, s57, 12288
s_add_u32 s72, s72, s50
s_mul_i32 s76, s57, 3584
s_add_u32 s57, s83, 1
s_and_b32 s57, s57, 3
s_lshl_b32 s65, s57, 12
s_mul_i32 s69, s57, 28672
s_add_u32 s69, s69, s48
s_mul_i32 s73, s57, 12288
s_add_u32 s73, s73, s50
s_mul_i32 s77, s57, 3584
s_add_u32 s57, s83, 2
s_and_b32 s57, s57, 3
s_lshl_b32 s66, s57, 12
s_mul_i32 s70, s57, 28672
s_add_u32 s70, s70, s48
s_mul_i32 s74, s57, 12288
s_add_u32 s74, s74, s50
s_mul_i32 s78, s57, 3584
s_add_u32 s57, s83, 3
s_and_b32 s57, s57, 3
s_lshl_b32 s67, s57, 12
s_mul_i32 s71, s57, 28672
s_add_u32 s71, s71, s48
s_mul_i32 s75, s57, 12288
s_add_u32 s75, s75, s50
s_mul_i32 s79, s57, 3584
s_lshl_b32 s57, s83, 1
s_add_u32 s57, s57, s38
s_add_u32 s57, s57, 0
s_and_b32 s57, s57, 7
s_lshl_b32 s57, s57, 12
s_add_u32 s80, s55, s57
s_sub_u32 s80, s80, s51
s_lshl_b32 s57, s83, 1
s_add_u32 s57, s57, s38
s_add_u32 s57, s57, 4
s_and_b32 s57, s57, 7
s_lshl_b32 s57, s57, 12
s_add_u32 s81, s55, s57
s_sub_u32 s81, s81, s51
s_add_u32 s83, s83, s38
s_and_b32 s83, s83, 3
s_lshl_b32 s82, s83, 14
s_add_u32 s82, s82, s46
s_sub_u32 s82, s82, s47
s_mul_i32 s53, s83, 393216
s_lshl_b32 s54, s38, 13
s_add_u32 m0, s54, 0
s_add_u32 s40, s53, 0
buffer_load_dwordx4 v11, s[8:11], s40 offen lds
s_add_u32 m0, s54, 32768
s_add_u32 s40, s53, 1024
buffer_load_dwordx4 v11, s[8:11], s40 offen lds
s_add_u32 m0, s54, 65536
s_add_u32 s40, s53, 2048
buffer_load_dwordx4 v11, s[8:11], s40 offen lds
s_add_u32 m0, s54, 1024
s_add_u32 s40, s53, 49152
buffer_load_dwordx4 v11, s[8:11], s40 offen lds
s_add_u32 m0, s54, 33792
s_add_u32 s40, s53, 50176
buffer_load_dwordx4 v11, s[8:11], s40 offen lds
s_add_u32 m0, s54, 66560
s_add_u32 s40, s53, 51200
buffer_load_dwordx4 v11, s[8:11], s40 offen lds
s_add_u32 m0, s54, 2048
s_add_u32 s40, s53, 98304
buffer_load_dwordx4 v11, s[8:11], s40 offen lds
s_add_u32 m0, s54, 34816
s_add_u32 s40, s53, 99328
buffer_load_dwordx4 v11, s[8:11], s40 offen lds
s_add_u32 m0, s54, 67584
s_add_u32 s40, s53, 100352
buffer_load_dwordx4 v11, s[8:11], s40 offen lds
s_add_u32 m0, s54, 3072
s_add_u32 s40, s53, 147456
buffer_load_dwordx4 v11, s[8:11], s40 offen lds
s_add_u32 s61, s61, 1
s_or_b32 s57, s44, s61
v_mov_b32 v22, s57
v_mov_b32 v23, s45
s_lshl_b32 s58, s37, 3
s_cmp_lg_u32 s38, 0
s_waitcnt vmcnt(10)
s_barrier
s_cbranch_scc1 Lsig516
s_mov_b64 exec, 1
buffer_store_dwordx2 v[22:23], v12, s[24:27], s58 offen sc1
s_mov_b64 exec, -1
Lsig516:
s_add_u32 m0, s54, 35840
s_add_u32 s40, s53, 148480
buffer_load_dwordx4 v11, s[8:11], s40 offen lds
s_add_u32 m0, s54, 68608
s_add_u32 s40, s53, 149504
buffer_load_dwordx4 v11, s[8:11], s40 offen lds
s_add_u32 m0, s54, 4096
s_add_u32 s40, s53, 196608
buffer_load_dwordx4 v11, s[8:11], s40 offen lds
s_add_u32 m0, s54, 36864
s_add_u32 s40, s53, 197632
buffer_load_dwordx4 v11, s[8:11], s40 offen lds
s_add_u32 m0, s54, 69632
s_add_u32 s40, s53, 198656
buffer_load_dwordx4 v11, s[8:11], s40 offen lds
s_add_u32 m0, s54, 5120
s_add_u32 s40, s53, 245760
buffer_load_dwordx4 v11, s[8:11], s40 offen lds
s_add_u32 m0, s54, 37888
s_add_u32 s40, s53, 246784
buffer_load_dwordx4 v11, s[8:11], s40 offen lds
s_add_u32 m0, s54, 70656
s_add_u32 s40, s53, 247808
buffer_load_dwordx4 v11, s[8:11], s40 offen lds
s_add_u32 m0, s54, 6144
s_add_u32 s40, s53, 294912
buffer_load_dwordx4 v11, s[8:11], s40 offen lds
s_add_u32 m0, s54, 38912
s_add_u32 s40, s53, 295936
buffer_load_dwordx4 v11, s[8:11], s40 offen lds
s_add_u32 m0, s54, 71680
s_add_u32 s40, s53, 296960
buffer_load_dwordx4 v11, s[8:11], s40 offen lds
s_add_u32 m0, s54, 7168
s_add_u32 s40, s53, 344064
buffer_load_dwordx4 v11, s[8:11], s40 offen lds
s_add_u32 m0, s54, 39936
s_add_u32 s40, s53, 345088
buffer_load_dwordx4 v11, s[8:11], s40 offen lds
s_add_u32 m0, s54, 72704
s_add_u32 s40, s53, 346112
buffer_load_dwordx4 v11, s[8:11], s40 offen lds
Llayer:
v_and_b32 v17, 1, v15
v_lshl_add_u32 v18, v14, 6, v16
v_lshl_add_u32 v32, v17, 5, v18
v_xor_b32 v33, 32, v32
v_add_u32 v34, 0x10000, v32
v_add_u32 v35, 0x10000, v33
s_lshr_b32 s57, s38, 1
s_add_u32 s57, s57, 1
s_lshl_b32 s57, s57, 15
s_and_b32 s58, s38, 1
s_lshl_b32 s58, s58, 5
v_xor_b32 v36, s58, v32
v_add_u32 v36, s57, v36
v_and_b32 v17, 15, v0
v_lshlrev_b32 v18, 2, v15
v_sub_u32 v17, v17, v18
s_mov_b32 s57, 0xf149f2ca
v_mov_b32 v19, s57
s_or_b32 s58, s36, s38
s_cmp_eq_u32 s58, 0
s_cselect_b32 s58, s57, 0
v_subrev_u32 v18, 0, v17
v_and_b32 v37, 0x80000001, v18
v_cmp_eq_u32 vcc, 0, v37
s_nop 1
v_cndmask_b32_e64 v40, v19, 0, vcc
v_cmp_eq_u32 vcc, 0x80000000, v37
s_nop 1
v_cndmask_b32_e64 v44, v19, 0, vcc
v_add_f32 v48, s58, v44
v_subrev_u32 v18, 1, v17
v_and_b32 v37, 0x80000001, v18
v_cmp_eq_u32 vcc, 0, v37
s_nop 1
v_cndmask_b32_e64 v41, v19, 0, vcc
v_cmp_eq_u32 vcc, 0x80000000, v37
s_nop 1
v_cndmask_b32_e64 v45, v19, 0, vcc
v_add_f32 v49, s58, v45
v_subrev_u32 v18, 2, v17
v_and_b32 v37, 0x80000001, v18
v_cmp_eq_u32 vcc, 0, v37
s_nop 1
v_cndmask_b32_e64 v42, v19, 0, vcc
v_cmp_eq_u32 vcc, 0x80000000, v37
s_nop 1
v_cndmask_b32_e64 v46, v19, 0, vcc
v_add_f32 v50, s58, v46
v_subrev_u32 v18, 3, v17
v_and_b32 v37, 0x80000001, v18
v_cmp_eq_u32 vcc, 0, v37
s_nop 1
v_cndmask_b32_e64 v43, v19, 0, vcc
v_cmp_eq_u32 vcc, 0x80000000, v37
s_nop 1
v_cndmask_b32_e64 v47, v19, 0, vcc
v_add_f32 v51, s58, v47
s_add_u32 s58, s43, s60
s_add_u32 s58, s58, 12582912
v_add_u32 v24, s58, v1
v_add_u32 v25, 0x4000, v24
s_lshr_b32 s58, s43, 4
s_add_u32 s58, s58, s60
s_add_u32 s58, s58, 14680064
v_add_u32 v27, s58, v60
s_lshl_b32 s57, s36, 17
s_add_u32 s58, s60, 12566528
s_add_u32 s58, s58, s57
s_lshr_b32 s57, s57, 4
s_add_u32 s57, s57, s60
s_add_u32 s57, s57, 14679040
s_cmp_eq_u32 s36, 0
s_cselect_b32 s58, 0xffff0000, s58
s_cselect_b32 s57, 0xffff0000, s57
v_add_u32 v26, s58, v1
v_add_u32 v37, s57, v60
v_lshlrev_b32 v39, 8, v14
v_lshl_add_u32 v39, v16, 2, v39
v_add_u32 v39, 41943040, v39
s_lshl_b32 s57, s38, 11
s_add_u32 s57, s57, 79872
v_lshl_add_u32 v61, v0, 3, s57
v_and_b32 v17, 15, v0
v_lshlrev_b32 v17, 5, v17
v_lshl_add_u32 v17, v15, 3, v17
v_add_u32 v62, s57, v17
v_lshl_add_u32 v63, v14, 5, v16
v_add_u32 v63, s57, v63
v_add_u32 v17, 9216, v17
v_lshlrev_b32 v38, 3, v0
s_cmp_ge_u32 s38, 2
s_cselect_b64 vcc, -1, 0
s_and_b32 s57, s38, 1
s_lshl_b32 s57, s57, 9
v_cndmask_b32 v38, v38, v17, vcc
s_add_u32 s57, s57, 79872
v_add_u32 v38, s57, v38
s_cmp_eq_u32 s39, 0
s_cbranch_scc1 Lna1
v_accvgpr_read_b32 v200, a200
v_accvgpr_read_b32 v201, a201
v_accvgpr_read_b32 v202, a202
v_accvgpr_read_b32 v203, a203
v_accvgpr_read_b32 v204, a204
v_accvgpr_read_b32 v205, a205
v_accvgpr_read_b32 v206, a206
v_accvgpr_read_b32 v207, a207
v_accvgpr_read_b32 v208, a208
v_accvgpr_read_b32 v209, a209
v_accvgpr_read_b32 v210, a210
v_accvgpr_read_b32 v211, a211
v_accvgpr_read_b32 v212, a212
v_accvgpr_read_b32 v213, a213
v_accvgpr_read_b32 v214, a214
v_accvgpr_read_b32 v215, a215
v_accvgpr_read_b32 v216, a216
v_accvgpr_read_b32 v217, a217
v_accvgpr_read_b32 v218, a218
v_accvgpr_read_b32 v219, a219
v_accvgpr_read_b32 v220, a220
v_accvgpr_read_b32 v221, a221
v_accvgpr_read_b32 v222, a222
v_accvgpr_read_b32 v223, a223
v_accvgpr_read_b32 v224, a224
v_accvgpr_read_b32 v225, a225
v_accvgpr_read_b32 v226, a226
v_accvgpr_read_b32 v227, a227
Lna1:
s_cmp_lg_u32 s38, 0
s_cbranch_scc1 Lpoll692x
s_mov_b32 s98, 0x40000
s_or_b32 s57, s44, s61
s_sub_u32 s58, 16, s61
Lpoll692:
buffer_load_dwordx2 v[248:249], v13, s[24:27], 0 offen sc1
Lpoll692p:
s_sub_u32 s98, s98, 1
s_cbranch_scc1 Lend
s_waitcnt vmcnt(0)
v_subrev_u32 v248, s57, v248
v_xor_b32 v249, s45, v249
v_cmp_gt_u32 vcc, s58, v248
v_cmp_eq_u32 s[2:3], 0, v249
s_nop 1
s_and_b64 vcc, vcc, s[2:3]
s_cmp_eq_u64 vcc, exec
s_cbranch_scc1 Lpoll692x
s_sleep 6
s_branch Lpoll692
Lpoll692x:
s_waitcnt vmcnt(0) lgkmcnt(0)
s_barrier
buffer_load_dwordx4 a[0:3], v24, s[24:27], s64 offen offset:0 sc1
buffer_load_dwordx4 a[64:67], v25, s[24:27], s64 offen offset:0 sc1
buffer_load_dwordx4 a[128:131], v26, s[24:27], s64 offen offset:0 sc1
buffer_load_dwordx4 a[4:7], v24, s[24:27], s64 offen offset:1024 sc1
buffer_load_dwordx4 a[68:71], v25, s[24:27], s64 offen offset:1024 sc1
buffer_load_dwordx4 a[132:135], v26, s[24:27], s64 offen offset:1024 sc1
buffer_load_dwordx4 a[8:11], v24, s[24:27], s64 offen offset:2048 sc1
buffer_load_dwordx4 a[72:75], v25, s[24:27], s64 offen offset:2048 sc1
buffer_load_dwordx4 a[136:139], v26, s[24:27], s64 offen offset:2048 sc1
s_cmp_eq_u32 s39, 0
s_cbranch_scc1 Lnwo
Lnwo:
s_cmp_lg_u32 s39, 0
s_cbranch_scc1 Lcp1
v_add_u32 v52, 0xffff8000, v36
s_and_b32 s57, s38, 1
s_lshl_b32 s57, s57, 5
v_xor_b32 v53, s57, v34
ds_read_b64_tr_b16 v[136:137], v52 offset:0
ds_read_b64_tr_b16 v[138:139], v52 offset:1024
ds_read_b64_tr_b16 v[140:141], v53 offset:0
ds_read_b64_tr_b16 v[142:143], v53 offset:1024
ds_read_b64_tr_b16 v[144:145], v52 offset:2048
ds_read_b64_tr_b16 v[146:147], v52 offset:3072
ds_read_b64_tr_b16 v[148:149], v53 offset:2048
ds_read_b64_tr_b16 v[150:151], v53 offset:3072
ds_read_b64_tr_b16 v[152:153], v52 offset:4096
ds_read_b64_tr_b16 v[154:155], v52 offset:5120
ds_read_b64_tr_b16 v[156:157], v53 offset:4096
ds_read_b64_tr_b16 v[158:159], v53 offset:5120
s_waitcnt lgkmcnt(8)
v_mfma_f32_16x16x32_bf16 a[200:203], v[136:139], v[28:31], 0
v_mfma_f32_16x16x32_bf16 a[204:207], v[140:143], v[28:31], 0
ds_read_b64_tr_b16 v[160:161], v52 offset:6144
ds_read_b64_tr_b16 v[162:163], v52 offset:7168
ds_read_b64_tr_b16 v[164:165], v53 offset:6144
ds_read_b64_tr_b16 v[166:167], v53 offset:7168
s_waitcnt lgkmcnt(8)
v_mfma_f32_16x16x32_bf16 a[200:203], v[144:147], v[28:31], a[200:203]
v_mfma_f32_16x16x32_bf16 a[204:207], v[148:151], v[28:31], a[204:207]
ds_read_b64_tr_b16 v[168:169], v52 offset:8192
ds_read_b64_tr_b16 v[170:171], v52 offset:9216
ds_read_b64_tr_b16 v[172:173], v53 offset:8192
ds_read_b64_tr_b16 v[174:175], v53 offset:9216
s_waitcnt lgkmcnt(8)
v_mfma_f32_16x16x32_bf16 a[200:203], v[152:155], v[28:31], a[200:203]
v_mfma_f32_16x16x32_bf16 a[204:207], v[156:159], v[28:31], a[204:207]
ds_read_b64_tr_b16 v[176:177], v52 offset:10240
ds_read_b64_tr_b16 v[178:179], v52 offset:11264
ds_read_b64_tr_b16 v[180:181], v53 offset:10240
ds_read_b64_tr_b16 v[182:183], v53 offset:11264
s_waitcnt lgkmcnt(8)
v_mfma_f32_16x16x32_bf16 a[200:203], v[160:163], v[28:31], a[200:203]
v_mfma_f32_16x16x32_bf16 a[204:207], v[164:167], v[28:31], a[204:207]
ds_read_b64_tr_b16 v[136:137], v52 offset:12288
ds_read_b64_tr_b16 v[138:139], v52 offset:13312
ds_read_b64_tr_b16 v[140:141], v53 offset:12288
ds_read_b64_tr_b16 v[142:143], v53 offset:13312
s_waitcnt lgkmcnt(8)
v_mfma_f32_16x16x32_bf16 a[200:203], v[168:171], v[28:31], a[200:203]
v_mfma_f32_16x16x32_bf16 a[204:207], v[172:175], v[28:31], a[204:207]
ds_read_b64_tr_b16 v[144:145], v52 offset:14336
ds_read_b64_tr_b16 v[146:147], v52 offset:15360
ds_read_b64_tr_b16 v[148:149], v53 offset:14336
ds_read_b64_tr_b16 v[150:151], v53 offset:15360
s_waitcnt lgkmcnt(8)
v_mfma_f32_16x16x32_bf16 a[200:203], v[176:179], v[28:31], a[200:203]
v_mfma_f32_16x16x32_bf16 a[204:207], v[180:183], v[28:31], a[204:207]
ds_read_b64_tr_b16 v[152:153], v52 offset:16384
ds_read_b64_tr_b16 v[154:155], v52 offset:17408
ds_read_b64_tr_b16 v[156:157], v53 offset:16384
ds_read_b64_tr_b16 v[158:159], v53 offset:17408
s_waitcnt lgkmcnt(8)
v_mfma_f32_16x16x32_bf16 a[200:203], v[136:139], v[28:31], a[200:203]
v_mfma_f32_16x16x32_bf16 a[204:207], v[140:143], v[28:31], a[204:207]
ds_read_b64_tr_b16 v[160:161], v52 offset:18432
ds_read_b64_tr_b16 v[162:163], v52 offset:19456
ds_read_b64_tr_b16 v[164:165], v53 offset:18432
ds_read_b64_tr_b16 v[166:167], v53 offset:19456
s_waitcnt lgkmcnt(8)
v_mfma_f32_16x16x32_bf16 a[200:203], v[144:147], v[28:31], a[200:203]
v_mfma_f32_16x16x32_bf16 a[204:207], v[148:151], v[28:31], a[204:207]
ds_read_b64_tr_b16 v[168:169], v52 offset:20480
ds_read_b64_tr_b16 v[170:171], v52 offset:21504
ds_read_b64_tr_b16 v[172:173], v53 offset:20480
ds_read_b64_tr_b16 v[174:175], v53 offset:21504
s_waitcnt lgkmcnt(8)
v_mfma_f32_16x16x32_bf16 a[200:203], v[152:155], v[28:31], a[200:203]
v_mfma_f32_16x16x32_bf16 a[204:207], v[156:159], v[28:31], a[204:207]
ds_read_b64_tr_b16 v[176:177], v52 offset:22528
ds_read_b64_tr_b16 v[178:179], v52 offset:23552
ds_read_b64_tr_b16 v[180:181], v53 offset:22528
ds_read_b64_tr_b16 v[182:183], v53 offset:23552
s_waitcnt lgkmcnt(8)
v_mfma_f32_16x16x32_bf16 a[200:203], v[160:163], v[28:31], a[200:203]
v_mfma_f32_16x16x32_bf16 a[204:207], v[164:167], v[28:31], a[204:207]
ds_read_b64_tr_b16 v[136:137], v52 offset:24576
ds_read_b64_tr_b16 v[138:139], v52 offset:25600
ds_read_b64_tr_b16 v[140:141], v53 offset:24576
ds_read_b64_tr_b16 v[142:143], v53 offset:25600
s_waitcnt lgkmcnt(8)
v_mfma_f32_16x16x32_bf16 a[200:203], v[168:171], v[28:31], a[200:203]
v_mfma_f32_16x16x32_bf16 a[204:207], v[172:175], v[28:31], a[204:207]
ds_read_b64_tr_b16 v[144:145], v52 offset:26624
ds_read_b64_tr_b16 v[146:147], v52 offset:27648
ds_read_b64_tr_b16 v[148:149], v53 offset:26624
ds_read_b64_tr_b16 v[150:151], v53 offset:27648
s_waitcnt lgkmcnt(8)
v_mfma_f32_16x16x32_bf16 a[200:203], v[176:179], v[28:31], a[200:203]
v_mfma_f32_16x16x32_bf16 a[204:207], v[180:183], v[28:31], a[204:207]
ds_read_b64_tr_b16 v[152:153], v52 offset:28672
ds_read_b64_tr_b16 v[154:155], v52 offset:29696
ds_read_b64_tr_b16 v[156:157], v53 offset:28672
ds_read_b64_tr_b16 v[158:159], v53 offset:29696
s_waitcnt lgkmcnt(8)
v_mfma_f32_16x16x32_bf16 a[200:203], v[136:139], v[28:31], a[200:203]
v_mfma_f32_16x16x32_bf16 a[204:207], v[140:143], v[28:31], a[204:207]
ds_read_b64_tr_b16 v[160:161], v52 offset:30720
ds_read_b64_tr_b16 v[162:163], v52 offset:31744
ds_read_b64_tr_b16 v[164:165], v53 offset:30720
ds_read_b64_tr_b16 v[166:167], v53 offset:31744
s_waitcnt lgkmcnt(8)
v_mfma_f32_16x16x32_bf16 a[200:203], v[144:147], v[28:31], a[200:203]
v_mfma_f32_16x16x32_bf16 a[204:207], v[148:151], v[28:31], a[204:207]
s_waitcnt lgkmcnt(4)
v_mfma_f32_16x16x32_bf16 a[200:203], v[152:155], v[28:31], a[200:203]
v_mfma_f32_16x16x32_bf16 a[204:207], v[156:159], v[28:31], a[204:207]
s_waitcnt lgkmcnt(0)
v_mfma_f32_16x16x32_bf16 a[200:203], v[160:163], v[28:31], a[200:203]
v_mfma_f32_16x16x32_bf16 a[204:207], v[164:167], v[28:31], a[204:207]
Lcp1:
ds_read_b64_tr_b16 v[136:137], v32 offset:0
ds_read_b64_tr_b16 v[138:139], v32 offset:1024
ds_read_b64_tr_b16 v[140:141], v33 offset:0
ds_read_b64_tr_b16 v[142:143], v33 offset:1024
ds_read_b64_tr_b16 v[144:145], v32 offset:32768
ds_read_b64_tr_b16 v[146:147], v32 offset:33792
ds_read_b64_tr_b16 v[148:149], v33 offset:32768
ds_read_b64_tr_b16 v[150:151], v33 offset:33792
ds_read_b64_tr_b16 v[152:153], v34 offset:0
ds_read_b64_tr_b16 v[154:155], v34 offset:1024
ds_read_b64_tr_b16 v[156:157], v35 offset:0
ds_read_b64_tr_b16 v[158:159], v35 offset:1024
ds_read_b64_tr_b16 v[160:161], v36 offset:0
ds_read_b64_tr_b16 v[162:163], v36 offset:1024
s_waitcnt vmcnt(6) lgkmcnt(0)
v_mfma_f32_16x16x32_bf16 v[64:67], v[136:139], a[0:3], 0
ds_read_b64_tr_b16 v[164:165], v32 offset:2048
buffer_load_dwordx4 a[12:15], v24, s[24:27], s64 offen offset:3072 sc1
v_mfma_f32_16x16x32_bf16 v[88:91], v[136:139], a[64:67], 0
ds_read_b64_tr_b16 v[166:167], v32 offset:3072
v_mfma_f32_16x16x32_bf16 v[68:71], v[140:143], a[0:3], 0
ds_read_b64_tr_b16 v[168:169], v33 offset:2048
buffer_load_dwordx4 a[76:79], v25, s[24:27], s64 offen offset:3072 sc1
v_mfma_f32_16x16x32_bf16 v[92:95], v[140:143], a[64:67], 0
ds_read_b64_tr_b16 v[170:171], v33 offset:3072
v_mfma_f32_16x16x32_bf16 v[72:75], v[144:147], a[0:3], 0
ds_read_b64_tr_b16 v[172:173], v32 offset:34816
buffer_load_dwordx4 a[140:143], v26, s[24:27], s64 offen offset:3072 sc1
v_mfma_f32_16x16x32_bf16 v[96:99], v[144:147], a[64:67], 0
ds_read_b64_tr_b16 v[174:175], v32 offset:35840
v_mfma_f32_16x16x32_bf16 v[76:79], v[148:151], a[0:3], 0
ds_read_b64_tr_b16 v[176:177], v33 offset:34816
buffer_load_dwordx4 a[16:19], v24, s[24:27], s65 offen offset:0 sc1
v_mfma_f32_16x16x32_bf16 v[100:103], v[148:151], a[64:67], 0
ds_read_b64_tr_b16 v[178:179], v33 offset:35840
v_mfma_f32_16x16x32_bf16 v[80:83], v[152:155], a[0:3], 0
ds_read_b64_tr_b16 v[180:181], v34 offset:2048
buffer_load_dwordx4 a[80:83], v25, s[24:27], s65 offen offset:0 sc1
v_mfma_f32_16x16x32_bf16 v[104:107], v[152:155], a[64:67], 0
ds_read_b64_tr_b16 v[182:183], v34 offset:3072
v_mfma_f32_16x16x32_bf16 v[84:87], v[156:159], a[0:3], 0
ds_read_b64_tr_b16 v[184:185], v35 offset:2048
buffer_load_dwordx4 a[144:147], v26, s[24:27], s65 offen offset:0 sc1
v_mfma_f32_16x16x32_bf16 v[108:111], v[156:159], a[64:67], 0
ds_read_b64_tr_b16 v[186:187], v35 offset:3072
v_mfma_f32_16x16x32_bf16 v[112:115], v[160:163], a[128:131], 0
ds_read_b64_tr_b16 v[188:189], v36 offset:2048
ds_read_b64_tr_b16 v[190:191], v36 offset:3072
s_waitcnt vmcnt(9) lgkmcnt(10)
v_mfma_f32_16x16x32_bf16 v[64:67], v[164:167], a[4:7], v[64:67]
ds_read_b64_tr_b16 v[136:137], v32 offset:4096
buffer_load_dwordx4 a[20:23], v24, s[24:27], s65 offen offset:1024 sc1
v_mfma_f32_16x16x32_bf16 v[88:91], v[164:167], a[68:71], v[88:91]
ds_read_b64_tr_b16 v[138:139], v32 offset:5120
v_mfma_f32_16x16x32_bf16 v[68:71], v[168:171], a[4:7], v[68:71]
ds_read_b64_tr_b16 v[140:141], v33 offset:4096
v_mfma_f32_16x16x32_bf16 v[92:95], v[168:171], a[68:71], v[92:95]
ds_read_b64_tr_b16 v[142:143], v33 offset:5120
s_waitcnt lgkmcnt(10)
v_mfma_f32_16x16x32_bf16 v[72:75], v[172:175], a[4:7], v[72:75]
ds_read_b64_tr_b16 v[144:145], v32 offset:36864
buffer_load_dwordx4 a[84:87], v25, s[24:27], s65 offen offset:1024 sc1
v_mfma_f32_16x16x32_bf16 v[96:99], v[172:175], a[68:71], v[96:99]
ds_read_b64_tr_b16 v[146:147], v32 offset:37888
v_mfma_f32_16x16x32_bf16 v[76:79], v[176:179], a[4:7], v[76:79]
ds_read_b64_tr_b16 v[148:149], v33 offset:36864
v_mfma_f32_16x16x32_bf16 v[100:103], v[176:179], a[68:71], v[100:103]
ds_read_b64_tr_b16 v[150:151], v33 offset:37888
s_waitcnt lgkmcnt(10)
v_mfma_f32_16x16x32_bf16 v[80:83], v[180:183], a[4:7], v[80:83]
ds_read_b64_tr_b16 v[152:153], v34 offset:4096
buffer_load_dwordx4 a[148:151], v26, s[24:27], s65 offen offset:1024 sc1
v_mfma_f32_16x16x32_bf16 v[104:107], v[180:183], a[68:71], v[104:107]
ds_read_b64_tr_b16 v[154:155], v34 offset:5120
v_mfma_f32_16x16x32_bf16 v[84:87], v[184:187], a[4:7], v[84:87]
ds_read_b64_tr_b16 v[156:157], v35 offset:4096
v_mfma_f32_16x16x32_bf16 v[108:111], v[184:187], a[68:71], v[108:111]
ds_read_b64_tr_b16 v[158:159], v35 offset:5120
s_waitcnt lgkmcnt(12)
v_mfma_f32_16x16x32_bf16 v[112:115], v[188:191], a[132:135], v[112:115]
ds_read_b64_tr_b16 v[160:161], v36 offset:4096
ds_read_b64_tr_b16 v[162:163], v36 offset:5120
s_waitcnt vmcnt(9) lgkmcnt(10)
v_mfma_f32_16x16x32_bf16 v[64:67], v[136:139], a[8:11], v[64:67]
ds_read_b64_tr_b16 v[164:165], v32 offset:6144
buffer_load_dwordx4 a[24:27], v24, s[24:27], s65 offen offset:2048 sc1
v_mfma_f32_16x16x32_bf16 v[88:91], v[136:139], a[72:75], v[88:91]
ds_read_b64_tr_b16 v[166:167], v32 offset:7168
buffer_load_dwordx4 a[88:91], v25, s[24:27], s65 offen offset:2048 sc1
v_mfma_f32_16x16x32_bf16 v[68:71], v[140:143], a[8:11], v[68:71]
ds_read_b64_tr_b16 v[168:169], v33 offset:6144
buffer_load_dwordx4 a[152:155], v26, s[24:27], s65 offen offset:2048 sc1
v_mfma_f32_16x16x32_bf16 v[92:95], v[140:143], a[72:75], v[92:95]
ds_read_b64_tr_b16 v[170:171], v33 offset:7168
s_waitcnt lgkmcnt(10)
v_mfma_f32_16x16x32_bf16 v[72:75], v[144:147], a[8:11], v[72:75]
ds_read_b64_tr_b16 v[172:173], v32 offset:38912
buffer_load_dwordx2 v[228:229], v27, s[24:27], 0 offen offset:0 sc1
v_mfma_f32_16x16x32_bf16 v[96:99], v[144:147], a[72:75], v[96:99]
ds_read_b64_tr_b16 v[174:175], v32 offset:39936
v_mfma_f32_16x16x32_bf16 v[76:79], v[148:151], a[8:11], v[76:79]
ds_read_b64_tr_b16 v[176:177], v33 offset:38912
buffer_load_dwordx2 v[230:231], v27, s[24:27], 0 offen offset:128 sc1
v_mfma_f32_16x16x32_bf16 v[100:103], v[148:151], a[72:75], v[100:103]
ds_read_b64_tr_b16 v[178:179], v33 offset:39936
buffer_load_dwordx2 v[232:233], v27, s[24:27], 0 offen offset:1024 sc1
s_waitcnt lgkmcnt(10)
v_mfma_f32_16x16x32_bf16 v[80:83], v[152:155], a[8:11], v[80:83]
ds_read_b64_tr_b16 v[180:181], v34 offset:6144
buffer_load_dwordx2 v[234:235], v27, s[24:27], 0 offen offset:1152 sc1
v_mfma_f32_16x16x32_bf16 v[104:107], v[152:155], a[72:75], v[104:107]
ds_read_b64_tr_b16 v[182:183], v34 offset:7168
v_mfma_f32_16x16x32_bf16 v[84:87], v[156:159], a[8:11], v[84:87]
ds_read_b64_tr_b16 v[184:185], v35 offset:6144
buffer_load_dwordx2 v[236:237], v37, s[24:27], 0 offen offset:0 sc1
v_mfma_f32_16x16x32_bf16 v[108:111], v[156:159], a[72:75], v[108:111]
ds_read_b64_tr_b16 v[186:187], v35 offset:7168
s_waitcnt lgkmcnt(12)
v_mfma_f32_16x16x32_bf16 v[112:115], v[160:163], a[136:139], v[112:115]
ds_read_b64_tr_b16 v[188:189], v36 offset:6144
ds_read_b64_tr_b16 v[190:191], v36 offset:7168
buffer_load_dwordx2 v[238:239], v37, s[24:27], 0 offen offset:128 sc1
s_waitcnt vmcnt(15) lgkmcnt(10)
v_mfma_f32_16x16x32_bf16 v[64:67], v[164:167], a[12:15], v[64:67]
ds_read_b64_tr_b16 v[136:137], v32 offset:8192
buffer_load_dwordx4 a[28:31], v24, s[24:27], s65 offen offset:3072 sc1
v_mfma_f32_16x16x32_bf16 v[88:91], v[164:167], a[76:79], v[88:91]
ds_read_b64_tr_b16 v[138:139], v32 offset:9216
v_mfma_f32_16x16x32_bf16 v[68:71], v[168:171], a[12:15], v[68:71]
ds_read_b64_tr_b16 v[140:141], v33 offset:8192
v_mfma_f32_16x16x32_bf16 v[92:95], v[168:171], a[76:79], v[92:95]
ds_read_b64_tr_b16 v[142:143], v33 offset:9216
s_waitcnt lgkmcnt(10)
v_mfma_f32_16x16x32_bf16 v[72:75], v[172:175], a[12:15], v[72:75]
ds_read_b64_tr_b16 v[144:145], v32 offset:40960
buffer_load_dwordx4 a[92:95], v25, s[24:27], s65 offen offset:3072 sc1
v_mfma_f32_16x16x32_bf16 v[96:99], v[172:175], a[76:79], v[96:99]
ds_read_b64_tr_b16 v[146:147], v32 offset:41984
v_mfma_f32_16x16x32_bf16 v[76:79], v[176:179], a[12:15], v[76:79]
ds_read_b64_tr_b16 v[148:149], v33 offset:40960
v_mfma_f32_16x16x32_bf16 v[100:103], v[176:179], a[76:79], v[100:103]
ds_read_b64_tr_b16 v[150:151], v33 offset:41984
s_waitcnt lgkmcnt(10)
v_mfma_f32_16x16x32_bf16 v[80:83], v[180:183], a[12:15], v[80:83]
ds_read_b64_tr_b16 v[152:153], v34 offset:8192
buffer_load_dwordx4 a[156:159], v26, s[24:27], s65 offen offset:3072 sc1
v_mfma_f32_16x16x32_bf16 v[104:107], v[180:183], a[76:79], v[104:107]
ds_read_b64_tr_b16 v[154:155], v34 offset:9216
v_mfma_f32_16x16x32_bf16 v[84:87], v[184:187], a[12:15], v[84:87]
ds_read_b64_tr_b16 v[156:157], v35 offset:8192
v_mfma_f32_16x16x32_bf16 v[108:111], v[184:187], a[76:79], v[108:111]
ds_read_b64_tr_b16 v[158:159], v35 offset:9216
s_waitcnt lgkmcnt(12)
v_mfma_f32_16x16x32_bf16 v[112:115], v[188:191], a[140:143], v[112:115]
ds_read_b64_tr_b16 v[160:161], v36 offset:8192
ds_read_b64_tr_b16 v[162:163], v36 offset:9216
s_waitcnt vmcnt(15) lgkmcnt(10)
v_mfma_f32_16x16x32_bf16 v[64:67], v[136:139], a[16:19], v[64:67]
ds_read_b64_tr_b16 v[164:165], v32 offset:10240
buffer_load_dwordx4 a[32:35], v24, s[24:27], s66 offen offset:0 sc1
v_mfma_f32_16x16x32_bf16 v[88:91], v[136:139], a[80:83], v[88:91]
ds_read_b64_tr_b16 v[166:167], v32 offset:11264
v_mfma_f32_16x16x32_bf16 v[68:71], v[140:143], a[16:19], v[68:71]
ds_read_b64_tr_b16 v[168:169], v33 offset:10240
v_mfma_f32_16x16x32_bf16 v[92:95], v[140:143], a[80:83], v[92:95]
ds_read_b64_tr_b16 v[170:171], v33 offset:11264
s_waitcnt lgkmcnt(10)
v_mfma_f32_16x16x32_bf16 v[72:75], v[144:147], a[16:19], v[72:75]
ds_read_b64_tr_b16 v[172:173], v32 offset:43008
buffer_load_dwordx4 a[96:99], v25, s[24:27], s66 offen offset:0 sc1
v_mfma_f32_16x16x32_bf16 v[96:99], v[144:147], a[80:83], v[96:99]
ds_read_b64_tr_b16 v[174:175], v32 offset:44032
v_mfma_f32_16x16x32_bf16 v[76:79], v[148:151], a[16:19], v[76:79]
ds_read_b64_tr_b16 v[176:177], v33 offset:43008
v_mfma_f32_16x16x32_bf16 v[100:103], v[148:151], a[80:83], v[100:103]
ds_read_b64_tr_b16 v[178:179], v33 offset:44032
s_waitcnt lgkmcnt(10)
v_mfma_f32_16x16x32_bf16 v[80:83], v[152:155], a[16:19], v[80:83]
ds_read_b64_tr_b16 v[180:181], v34 offset:10240
buffer_load_dwordx4 a[160:163], v26, s[24:27], s66 offen offset:0 sc1
v_mfma_f32_16x16x32_bf16 v[104:107], v[152:155], a[80:83], v[104:107]
ds_read_b64_tr_b16 v[182:183], v34 offset:11264
v_mfma_f32_16x16x32_bf16 v[84:87], v[156:159], a[16:19], v[84:87]
ds_read_b64_tr_b16 v[184:185], v35 offset:10240
v_mfma_f32_16x16x32_bf16 v[108:111], v[156:159], a[80:83], v[108:111]
ds_read_b64_tr_b16 v[186:187], v35 offset:11264
s_waitcnt lgkmcnt(12)
v_mfma_f32_16x16x32_bf16 v[112:115], v[160:163], a[144:147], v[112:115]
ds_read_b64_tr_b16 v[188:189], v36 offset:10240
ds_read_b64_tr_b16 v[190:191], v36 offset:11264
s_waitcnt vmcnt(15) lgkmcnt(10)
v_mfma_f32_16x16x32_bf16 v[64:67], v[164:167], a[20:23], v[64:67]
ds_read_b64_tr_b16 v[136:137], v32 offset:12288
buffer_load_dwordx4 a[36:39], v24, s[24:27], s66 offen offset:1024 sc1
v_mfma_f32_16x16x32_bf16 v[88:91], v[164:167], a[84:87], v[88:91]
ds_read_b64_tr_b16 v[138:139], v32 offset:13312
v_mfma_f32_16x16x32_bf16 v[68:71], v[168:171], a[20:23], v[68:71]
ds_read_b64_tr_b16 v[140:141], v33 offset:12288
v_mfma_f32_16x16x32_bf16 v[92:95], v[168:171], a[84:87], v[92:95]
ds_read_b64_tr_b16 v[142:143], v33 offset:13312
s_waitcnt lgkmcnt(10)
v_mfma_f32_16x16x32_bf16 v[72:75], v[172:175], a[20:23], v[72:75]
ds_read_b64_tr_b16 v[144:145], v32 offset:45056
buffer_load_dwordx4 a[100:103], v25, s[24:27], s66 offen offset:1024 sc1
v_mfma_f32_16x16x32_bf16 v[96:99], v[172:175], a[84:87], v[96:99]
ds_read_b64_tr_b16 v[146:147], v32 offset:46080
v_mfma_f32_16x16x32_bf16 v[76:79], v[176:179], a[20:23], v[76:79]
ds_read_b64_tr_b16 v[148:149], v33 offset:45056
v_mfma_f32_16x16x32_bf16 v[100:103], v[176:179], a[84:87], v[100:103]
ds_read_b64_tr_b16 v[150:151], v33 offset:46080
s_waitcnt lgkmcnt(10)
v_mfma_f32_16x16x32_bf16 v[80:83], v[180:183], a[20:23], v[80:83]
ds_read_b64_tr_b16 v[152:153], v34 offset:12288
buffer_load_dwordx4 a[164:167], v26, s[24:27], s66 offen offset:1024 sc1
v_mfma_f32_16x16x32_bf16 v[104:107], v[180:183], a[84:87], v[104:107]
ds_read_b64_tr_b16 v[154:155], v34 offset:13312
v_mfma_f32_16x16x32_bf16 v[84:87], v[184:187], a[20:23], v[84:87]
ds_read_b64_tr_b16 v[156:157], v35 offset:12288
v_mfma_f32_16x16x32_bf16 v[108:111], v[184:187], a[84:87], v[108:111]
ds_read_b64_tr_b16 v[158:159], v35 offset:13312
s_waitcnt lgkmcnt(12)
v_mfma_f32_16x16x32_bf16 v[112:115], v[188:191], a[148:151], v[112:115]
ds_read_b64_tr_b16 v[160:161], v36 offset:12288
ds_read_b64_tr_b16 v[162:163], v36 offset:13312
s_waitcnt vmcnt(15) lgkmcnt(10)
v_mfma_f32_16x16x32_bf16 v[64:67], v[136:139], a[24:27], v[64:67]
ds_read_b64_tr_b16 v[164:165], v32 offset:14336
buffer_load_dwordx4 a[40:43], v24, s[24:27], s66 offen offset:2048 sc1
v_mfma_f32_16x16x32_bf16 v[88:91], v[136:139], a[88:91], v[88:91]
ds_read_b64_tr_b16 v[166:167], v32 offset:15360
v_mfma_f32_16x16x32_bf16 v[68:71], v[140:143], a[24:27], v[68:71]
ds_read_b64_tr_b16 v[168:169], v33 offset:14336
v_mfma_f32_16x16x32_bf16 v[92:95], v[140:143], a[88:91], v[92:95]
ds_read_b64_tr_b16 v[170:171], v33 offset:15360
s_waitcnt lgkmcnt(10)
v_mfma_f32_16x16x32_bf16 v[72:75], v[144:147], a[24:27], v[72:75]
ds_read_b64_tr_b16 v[172:173], v32 offset:47104
buffer_load_dwordx4 a[104:107], v25, s[24:27], s66 offen offset:2048 sc1
v_mfma_f32_16x16x32_bf16 v[96:99], v[144:147], a[88:91], v[96:99]
ds_read_b64_tr_b16 v[174:175], v32 offset:48128
v_mfma_f32_16x16x32_bf16 v[76:79], v[148:151], a[24:27], v[76:79]
ds_read_b64_tr_b16 v[176:177], v33 offset:47104
v_mfma_f32_16x16x32_bf16 v[100:103], v[148:151], a[88:91], v[100:103]
ds_read_b64_tr_b16 v[178:179], v33 offset:48128
s_waitcnt lgkmcnt(10)
v_mfma_f32_16x16x32_bf16 v[80:83], v[152:155], a[24:27], v[80:83]
ds_read_b64_tr_b16 v[180:181], v34 offset:14336
buffer_load_dwordx4 a[168:171], v26, s[24:27], s66 offen offset:2048 sc1
v_mfma_f32_16x16x32_bf16 v[104:107], v[152:155], a[88:91], v[104:107]
ds_read_b64_tr_b16 v[182:183], v34 offset:15360
v_mfma_f32_16x16x32_bf16 v[84:87], v[156:159], a[24:27], v[84:87]
ds_read_b64_tr_b16 v[184:185], v35 offset:14336
v_mfma_f32_16x16x32_bf16 v[108:111], v[156:159], a[88:91], v[108:111]
ds_read_b64_tr_b16 v[186:187], v35 offset:15360
s_waitcnt lgkmcnt(12)
v_mfma_f32_16x16x32_bf16 v[112:115], v[160:163], a[152:155], v[112:115]
ds_read_b64_tr_b16 v[188:189], v36 offset:14336
ds_read_b64_tr_b16 v[190:191], v36 offset:15360
s_waitcnt vmcnt(9) lgkmcnt(10)
v_mfma_f32_16x16x32_bf16 v[64:67], v[164:167], a[28:31], v[64:67]
ds_read_b64_tr_b16 v[136:137], v32 offset:16384
buffer_load_dwordx4 a[44:47], v24, s[24:27], s66 offen offset:3072 sc1
v_mfma_f32_16x16x32_bf16 v[88:91], v[164:167], a[92:95], v[88:91]
ds_read_b64_tr_b16 v[138:139], v32 offset:17408
v_mfma_f32_16x16x32_bf16 v[68:71], v[168:171], a[28:31], v[68:71]
ds_read_b64_tr_b16 v[140:141], v33 offset:16384
v_mfma_f32_16x16x32_bf16 v[92:95], v[168:171], a[92:95], v[92:95]
ds_read_b64_tr_b16 v[142:143], v33 offset:17408
s_waitcnt lgkmcnt(10)
v_mfma_f32_16x16x32_bf16 v[72:75], v[172:175], a[28:31], v[72:75]
ds_read_b64_tr_b16 v[144:145], v32 offset:49152
buffer_load_dwordx4 a[108:111], v25, s[24:27], s66 offen offset:3072 sc1
v_mfma_f32_16x16x32_bf16 v[96:99], v[172:175], a[92:95], v[96:99]
ds_read_b64_tr_b16 v[146:147], v32 offset:50176
v_mfma_f32_16x16x32_bf16 v[76:79], v[176:179], a[28:31], v[76:79]
ds_read_b64_tr_b16 v[148:149], v33 offset:49152
v_mfma_f32_16x16x32_bf16 v[100:103], v[176:179], a[92:95], v[100:103]
ds_read_b64_tr_b16 v[150:151], v33 offset:50176
s_waitcnt lgkmcnt(10)
v_mfma_f32_16x16x32_bf16 v[80:83], v[180:183], a[28:31], v[80:83]
ds_read_b64_tr_b16 v[152:153], v34 offset:16384
buffer_load_dwordx4 a[172:175], v26, s[24:27], s66 offen offset:3072 sc1
v_mfma_f32_16x16x32_bf16 v[104:107], v[180:183], a[92:95], v[104:107]
ds_read_b64_tr_b16 v[154:155], v34 offset:17408
v_mfma_f32_16x16x32_bf16 v[84:87], v[184:187], a[28:31], v[84:87]
ds_read_b64_tr_b16 v[156:157], v35 offset:16384
v_mfma_f32_16x16x32_bf16 v[108:111], v[184:187], a[92:95], v[108:111]
ds_read_b64_tr_b16 v[158:159], v35 offset:17408
s_waitcnt lgkmcnt(12)
v_mfma_f32_16x16x32_bf16 v[112:115], v[188:191], a[156:159], v[112:115]
ds_read_b64_tr_b16 v[160:161], v36 offset:16384
ds_read_b64_tr_b16 v[162:163], v36 offset:17408
s_waitcnt vmcnt(9) lgkmcnt(10)
v_mfma_f32_16x16x32_bf16 v[64:67], v[136:139], a[32:35], v[64:67]
ds_read_b64_tr_b16 v[164:165], v32 offset:18432
v_add_f32 v228, v228, v230
v_mfma_f32_16x16x32_bf16 v[88:91], v[136:139], a[96:99], v[88:91]
ds_read_b64_tr_b16 v[166:167], v32 offset:19456
buffer_load_dwordx4 a[48:51], v24, s[24:27], s67 offen offset:0 sc1
v_mfma_f32_16x16x32_bf16 v[68:71], v[140:143], a[32:35], v[68:71]
ds_read_b64_tr_b16 v[168:169], v33 offset:18432
v_add_f32 v232, v232, v234
v_mfma_f32_16x16x32_bf16 v[92:95], v[140:143], a[96:99], v[92:95]
ds_read_b64_tr_b16 v[170:171], v33 offset:19456
v_add_f32 v236, v236, v238
s_waitcnt lgkmcnt(10)
v_mfma_f32_16x16x32_bf16 v[72:75], v[144:147], a[32:35], v[72:75]
ds_read_b64_tr_b16 v[172:173], v32 offset:51200
buffer_load_dwordx4 a[112:115], v25, s[24:27], s67 offen offset:0 sc1
v_mfma_f32_16x16x32_bf16 v[96:99], v[144:147], a[96:99], v[96:99]
ds_read_b64_tr_b16 v[174:175], v32 offset:52224
v_mfma_f32_16x16x32_bf16 v[76:79], v[148:151], a[32:35], v[76:79]
ds_read_b64_tr_b16 v[176:177], v33 offset:51200
v_add_f32 v229, v229, v231
v_mfma_f32_16x16x32_bf16 v[100:103], v[148:151], a[96:99], v[100:103]
ds_read_b64_tr_b16 v[178:179], v33 offset:52224
v_add_f32 v233, v233, v235
s_waitcnt lgkmcnt(10)
v_mfma_f32_16x16x32_bf16 v[80:83], v[152:155], a[32:35], v[80:83]
ds_read_b64_tr_b16 v[180:181], v34 offset:18432
v_add_f32 v237, v237, v239
v_mfma_f32_16x16x32_bf16 v[104:107], v[152:155], a[96:99], v[104:107]
ds_read_b64_tr_b16 v[182:183], v34 offset:19456
v_mfma_f32_16x16x32_bf16 v[84:87], v[156:159], a[32:35], v[84:87]
ds_read_b64_tr_b16 v[184:185], v35 offset:18432
buffer_load_dwordx4 a[176:179], v26, s[24:27], s67 offen offset:0 sc1
v_mfma_f32_16x16x32_bf16 v[108:111], v[156:159], a[96:99], v[108:111]
ds_read_b64_tr_b16 v[186:187], v35 offset:19456
v_mov_b32 v17, v228
s_waitcnt lgkmcnt(12)
v_mfma_f32_16x16x32_bf16 v[112:115], v[160:163], a[160:163], v[112:115]
ds_read_b64_tr_b16 v[188:189], v36 offset:18432
ds_read_b64_tr_b16 v[190:191], v36 offset:19456
v_mov_b32 v18, v232
s_waitcnt vmcnt(9) lgkmcnt(10)
v_mfma_f32_16x16x32_bf16 v[64:67], v[164:167], a[36:39], v[64:67]
ds_read_b64_tr_b16 v[136:137], v32 offset:20480
v_mov_b32 v19, v236
v_mfma_f32_16x16x32_bf16 v[88:91], v[164:167], a[100:103], v[88:91]
ds_read_b64_tr_b16 v[138:139], v32 offset:21504
buffer_load_dwordx4 a[52:55], v24, s[24:27], s67 offen offset:1024 sc1
v_mfma_f32_16x16x32_bf16 v[68:71], v[168:171], a[36:39], v[68:71]
ds_read_b64_tr_b16 v[140:141], v33 offset:20480
v_permlane16_swap_b32 v228, v17
v_mfma_f32_16x16x32_bf16 v[92:95], v[168:171], a[100:103], v[92:95]
ds_read_b64_tr_b16 v[142:143], v33 offset:21504
v_permlane16_swap_b32 v232, v18
s_waitcnt lgkmcnt(10)
v_mfma_f32_16x16x32_bf16 v[72:75], v[172:175], a[36:39], v[72:75]
ds_read_b64_tr_b16 v[144:145], v32 offset:53248
buffer_load_dwordx4 a[116:119], v25, s[24:27], s67 offen offset:1024 sc1
v_mfma_f32_16x16x32_bf16 v[96:99], v[172:175], a[100:103], v[96:99]
ds_read_b64_tr_b16 v[146:147], v32 offset:54272
v_mfma_f32_16x16x32_bf16 v[76:79], v[176:179], a[36:39], v[76:79]
ds_read_b64_tr_b16 v[148:149], v33 offset:53248
v_permlane16_swap_b32 v236, v19
v_mfma_f32_16x16x32_bf16 v[100:103], v[176:179], a[100:103], v[100:103]
ds_read_b64_tr_b16 v[150:151], v33 offset:54272
v_add_f32 v228, v228, v17
s_waitcnt lgkmcnt(10)
v_mfma_f32_16x16x32_bf16 v[80:83], v[180:183], a[36:39], v[80:83]
ds_read_b64_tr_b16 v[152:153], v34 offset:20480
v_add_f32 v232, v232, v18
v_mfma_f32_16x16x32_bf16 v[104:107], v[180:183], a[100:103], v[104:107]
ds_read_b64_tr_b16 v[154:155], v34 offset:21504
v_mfma_f32_16x16x32_bf16 v[84:87], v[184:187], a[36:39], v[84:87]
ds_read_b64_tr_b16 v[156:157], v35 offset:20480
buffer_load_dwordx4 a[180:183], v26, s[24:27], s67 offen offset:1024 sc1
v_mfma_f32_16x16x32_bf16 v[108:111], v[184:187], a[100:103], v[108:111]
ds_read_b64_tr_b16 v[158:159], v35 offset:21504
v_add_f32 v236, v236, v19
s_waitcnt lgkmcnt(12)
v_mfma_f32_16x16x32_bf16 v[112:115], v[188:191], a[164:167], v[112:115]
ds_read_b64_tr_b16 v[160:161], v36 offset:20480
ds_read_b64_tr_b16 v[162:163], v36 offset:21504
v_mov_b32 v17, v228
s_waitcnt vmcnt(9) lgkmcnt(10)
v_mfma_f32_16x16x32_bf16 v[64:67], v[136:139], a[40:43], v[64:67]
ds_read_b64_tr_b16 v[164:165], v32 offset:22528
v_mov_b32 v18, v232
v_mfma_f32_16x16x32_bf16 v[88:91], v[136:139], a[104:107], v[88:91]
ds_read_b64_tr_b16 v[166:167], v32 offset:23552
buffer_load_dwordx4 a[56:59], v24, s[24:27], s67 offen offset:2048 sc1
v_mfma_f32_16x16x32_bf16 v[68:71], v[140:143], a[40:43], v[68:71]
ds_read_b64_tr_b16 v[168:169], v33 offset:22528
v_mov_b32 v19, v236
v_mfma_f32_16x16x32_bf16 v[92:95], v[140:143], a[104:107], v[92:95]
ds_read_b64_tr_b16 v[170:171], v33 offset:23552
v_permlane32_swap_b32 v228, v17
s_waitcnt lgkmcnt(10)
v_mfma_f32_16x16x32_bf16 v[72:75], v[144:147], a[40:43], v[72:75]
ds_read_b64_tr_b16 v[172:173], v32 offset:55296
buffer_load_dwordx4 a[120:123], v25, s[24:27], s67 offen offset:2048 sc1
v_mfma_f32_16x16x32_bf16 v[96:99], v[144:147], a[104:107], v[96:99]
ds_read_b64_tr_b16 v[174:175], v32 offset:56320
v_mfma_f32_16x16x32_bf16 v[76:79], v[148:151], a[40:43], v[76:79]
ds_read_b64_tr_b16 v[176:177], v33 offset:55296
v_permlane32_swap_b32 v232, v18
v_mfma_f32_16x16x32_bf16 v[100:103], v[148:151], a[104:107], v[100:103]
ds_read_b64_tr_b16 v[178:179], v33 offset:56320
v_permlane32_swap_b32 v236, v19
s_waitcnt lgkmcnt(10)
v_mfma_f32_16x16x32_bf16 v[80:83], v[152:155], a[40:43], v[80:83]
ds_read_b64_tr_b16 v[180:181], v34 offset:22528
v_add_f32 v228, v228, v17
v_mfma_f32_16x16x32_bf16 v[104:107], v[152:155], a[104:107], v[104:107]
ds_read_b64_tr_b16 v[182:183], v34 offset:23552
v_mfma_f32_16x16x32_bf16 v[84:87], v[156:159], a[40:43], v[84:87]
ds_read_b64_tr_b16 v[184:185], v35 offset:22528
buffer_load_dwordx4 a[184:187], v26, s[24:27], s67 offen offset:2048 sc1
v_mfma_f32_16x16x32_bf16 v[108:111], v[156:159], a[104:107], v[108:111]
ds_read_b64_tr_b16 v[186:187], v35 offset:23552
v_add_f32 v232, v232, v18
s_waitcnt lgkmcnt(12)
v_mfma_f32_16x16x32_bf16 v[112:115], v[160:163], a[168:171], v[112:115]
ds_read_b64_tr_b16 v[188:189], v36 offset:22528
ds_read_b64_tr_b16 v[190:191], v36 offset:23552
v_add_f32 v236, v236, v19
s_waitcnt vmcnt(9) lgkmcnt(10)
v_mfma_f32_16x16x32_bf16 v[64:67], v[164:167], a[44:47], v[64:67]
ds_read_b64_tr_b16 v[136:137], v32 offset:24576
v_mov_b32 v17, v229
v_mfma_f32_16x16x32_bf16 v[88:91], v[164:167], a[108:111], v[88:91]
ds_read_b64_tr_b16 v[138:139], v32 offset:25600
buffer_load_dwordx4 a[60:63], v24, s[24:27], s67 offen offset:3072 sc1
v_mfma_f32_16x16x32_bf16 v[68:71], v[168:171], a[44:47], v[68:71]
ds_read_b64_tr_b16 v[140:141], v33 offset:24576
v_mov_b32 v18, v233
v_mfma_f32_16x16x32_bf16 v[92:95], v[168:171], a[108:111], v[92:95]
ds_read_b64_tr_b16 v[142:143], v33 offset:25600
v_mov_b32 v19, v237
s_waitcnt lgkmcnt(10)
v_mfma_f32_16x16x32_bf16 v[72:75], v[172:175], a[44:47], v[72:75]
ds_read_b64_tr_b16 v[144:145], v32 offset:57344
buffer_load_dwordx4 a[124:127], v25, s[24:27], s67 offen offset:3072 sc1
v_mfma_f32_16x16x32_bf16 v[96:99], v[172:175], a[108:111], v[96:99]
ds_read_b64_tr_b16 v[146:147], v32 offset:58368
v_mfma_f32_16x16x32_bf16 v[76:79], v[176:179], a[44:47], v[76:79]
ds_read_b64_tr_b16 v[148:149], v33 offset:57344
v_permlane16_swap_b32 v229, v17
v_mfma_f32_16x16x32_bf16 v[100:103], v[176:179], a[108:111], v[100:103]
ds_read_b64_tr_b16 v[150:151], v33 offset:58368
v_permlane16_swap_b32 v233, v18
s_waitcnt lgkmcnt(10)
v_mfma_f32_16x16x32_bf16 v[80:83], v[180:183], a[44:47], v[80:83]
ds_read_b64_tr_b16 v[152:153], v34 offset:24576
v_permlane16_swap_b32 v237, v19
v_mfma_f32_16x16x32_bf16 v[104:107], v[180:183], a[108:111], v[104:107]
ds_read_b64_tr_b16 v[154:155], v34 offset:25600
v_mfma_f32_16x16x32_bf16 v[84:87], v[184:187], a[44:47], v[84:87]
ds_read_b64_tr_b16 v[156:157], v35 offset:24576
buffer_load_dwordx4 a[188:191], v26, s[24:27], s67 offen offset:3072 sc1
v_mfma_f32_16x16x32_bf16 v[108:111], v[184:187], a[108:111], v[108:111]
ds_read_b64_tr_b16 v[158:159], v35 offset:25600
v_add_f32 v229, v229, v17
s_waitcnt lgkmcnt(12)
v_mfma_f32_16x16x32_bf16 v[112:115], v[188:191], a[172:175], v[112:115]
ds_read_b64_tr_b16 v[160:161], v36 offset:24576
ds_read_b64_tr_b16 v[162:163], v36 offset:25600
v_add_f32 v233, v233, v18
s_waitcnt vmcnt(9) lgkmcnt(10)
v_mfma_f32_16x16x32_bf16 v[64:67], v[136:139], a[48:51], v[64:67]
ds_read_b64_tr_b16 v[164:165], v32 offset:26624
v_add_f32 v237, v237, v19
v_mfma_f32_16x16x32_bf16 v[88:91], v[136:139], a[112:115], v[88:91]
ds_read_b64_tr_b16 v[166:167], v32 offset:27648
v_mov_b32 v17, v229
v_mfma_f32_16x16x32_bf16 v[68:71], v[140:143], a[48:51], v[68:71]
ds_read_b64_tr_b16 v[168:169], v33 offset:26624
v_mov_b32 v18, v233
v_mfma_f32_16x16x32_bf16 v[92:95], v[140:143], a[112:115], v[92:95]
ds_read_b64_tr_b16 v[170:171], v33 offset:27648
s_waitcnt lgkmcnt(10)
v_mfma_f32_16x16x32_bf16 v[72:75], v[144:147], a[48:51], v[72:75]
ds_read_b64_tr_b16 v[172:173], v32 offset:59392
v_mov_b32 v19, v237
v_mfma_f32_16x16x32_bf16 v[96:99], v[144:147], a[112:115], v[96:99]
ds_read_b64_tr_b16 v[174:175], v32 offset:60416
v_mfma_f32_16x16x32_bf16 v[76:79], v[148:151], a[48:51], v[76:79]
ds_read_b64_tr_b16 v[176:177], v33 offset:59392
v_permlane32_swap_b32 v229, v17
v_mfma_f32_16x16x32_bf16 v[100:103], v[148:151], a[112:115], v[100:103]
ds_read_b64_tr_b16 v[178:179], v33 offset:60416
s_waitcnt lgkmcnt(10)
v_mfma_f32_16x16x32_bf16 v[80:83], v[152:155], a[48:51], v[80:83]
ds_read_b64_tr_b16 v[180:181], v34 offset:26624
v_permlane32_swap_b32 v233, v18
v_mfma_f32_16x16x32_bf16 v[104:107], v[152:155], a[112:115], v[104:107]
ds_read_b64_tr_b16 v[182:183], v34 offset:27648
v_mfma_f32_16x16x32_bf16 v[84:87], v[156:159], a[48:51], v[84:87]
ds_read_b64_tr_b16 v[184:185], v35 offset:26624
v_permlane32_swap_b32 v237, v19
v_mfma_f32_16x16x32_bf16 v[108:111], v[156:159], a[112:115], v[108:111]
ds_read_b64_tr_b16 v[186:187], v35 offset:27648
s_waitcnt lgkmcnt(12)
v_mfma_f32_16x16x32_bf16 v[112:115], v[160:163], a[176:179], v[112:115]
ds_read_b64_tr_b16 v[188:189], v36 offset:26624
ds_read_b64_tr_b16 v[190:191], v36 offset:27648
v_add_f32 v229, v229, v17
s_waitcnt vmcnt(6) lgkmcnt(10)
v_mfma_f32_16x16x32_bf16 v[64:67], v[164:167], a[52:55], v[64:67]
ds_read_b64_tr_b16 v[136:137], v32 offset:28672
v_add_f32 v233, v233, v18
v_mfma_f32_16x16x32_bf16 v[88:91], v[164:167], a[116:119], v[88:91]
ds_read_b64_tr_b16 v[138:139], v32 offset:29696
v_add_f32 v237, v237, v19
v_mfma_f32_16x16x32_bf16 v[68:71], v[168:171], a[52:55], v[68:71]
ds_read_b64_tr_b16 v[140:141], v33 offset:28672
v_mul_f32 v228, 0x3b000000, v228
v_mfma_f32_16x16x32_bf16 v[92:95], v[168:171], a[116:119], v[92:95]
ds_read_b64_tr_b16 v[142:143], v33 offset:29696
s_waitcnt lgkmcnt(10)
v_mfma_f32_16x16x32_bf16 v[72:75], v[172:175], a[52:55], v[72:75]
ds_read_b64_tr_b16 v[144:145], v32 offset:61440
v_mul_f32 v232, 0x3b000000, v232
v_mfma_f32_16x16x32_bf16 v[96:99], v[172:175], a[116:119], v[96:99]
ds_read_b64_tr_b16 v[146:147], v32 offset:62464
v_mfma_f32_16x16x32_bf16 v[76:79], v[176:179], a[52:55], v[76:79]
ds_read_b64_tr_b16 v[148:149], v33 offset:61440
v_mul_f32 v236, 0x3b000000, v236
v_mfma_f32_16x16x32_bf16 v[100:103], v[176:179], a[116:119], v[100:103]
ds_read_b64_tr_b16 v[150:151], v33 offset:62464
s_waitcnt lgkmcnt(10)
v_mfma_f32_16x16x32_bf16 v[80:83], v[180:183], a[52:55], v[80:83]
ds_read_b64_tr_b16 v[152:153], v34 offset:28672
v_mul_f32 v229, 0x3b000000, v229
v_mfma_f32_16x16x32_bf16 v[104:107], v[180:183], a[116:119], v[104:107]
ds_read_b64_tr_b16 v[154:155], v34 offset:29696
v_mfma_f32_16x16x32_bf16 v[84:87], v[184:187], a[52:55], v[84:87]
ds_read_b64_tr_b16 v[156:157], v35 offset:28672
v_mul_f32 v233, 0x3b000000, v233
v_mfma_f32_16x16x32_bf16 v[108:111], v[184:187], a[116:119], v[108:111]
ds_read_b64_tr_b16 v[158:159], v35 offset:29696
s_waitcnt lgkmcnt(12)
v_mfma_f32_16x16x32_bf16 v[112:115], v[188:191], a[180:183], v[112:115]
ds_read_b64_tr_b16 v[160:161], v36 offset:28672
ds_read_b64_tr_b16 v[162:163], v36 offset:29696
v_mul_f32 v237, 0x3b000000, v237
s_waitcnt vmcnt(3) lgkmcnt(10)
v_mfma_f32_16x16x32_bf16 v[64:67], v[136:139], a[56:59], v[64:67]
ds_read_b64_tr_b16 v[164:165], v32 offset:30720
v_fma_f32 v229, -v228, v228, v229
v_mfma_f32_16x16x32_bf16 v[88:91], v[136:139], a[120:123], v[88:91]
ds_read_b64_tr_b16 v[166:167], v32 offset:31744
v_fma_f32 v233, -v232, v232, v233
v_mfma_f32_16x16x32_bf16 v[68:71], v[140:143], a[56:59], v[68:71]
ds_read_b64_tr_b16 v[168:169], v33 offset:30720
v_fma_f32 v237, -v236, v236, v237
v_mfma_f32_16x16x32_bf16 v[92:95], v[140:143], a[120:123], v[92:95]
ds_read_b64_tr_b16 v[170:171], v33 offset:31744
s_waitcnt lgkmcnt(10)
v_mfma_f32_16x16x32_bf16 v[72:75], v[144:147], a[56:59], v[72:75]
ds_read_b64_tr_b16 v[172:173], v32 offset:63488
v_max_f32 v229, 0, v229
v_mfma_f32_16x16x32_bf16 v[96:99], v[144:147], a[120:123], v[96:99]
ds_read_b64_tr_b16 v[174:175], v32 offset:64512
v_mfma_f32_16x16x32_bf16 v[76:79], v[148:151], a[56:59], v[76:79]
ds_read_b64_tr_b16 v[176:177], v33 offset:63488
v_max_f32 v233, 0, v233
v_mfma_f32_16x16x32_bf16 v[100:103], v[148:151], a[120:123], v[100:103]
ds_read_b64_tr_b16 v[178:179], v33 offset:64512
s_waitcnt lgkmcnt(10)
v_mfma_f32_16x16x32_bf16 v[80:83], v[152:155], a[56:59], v[80:83]
ds_read_b64_tr_b16 v[180:181], v34 offset:30720
v_max_f32 v237, 0, v237
v_mfma_f32_16x16x32_bf16 v[104:107], v[152:155], a[120:123], v[104:107]
ds_read_b64_tr_b16 v[182:183], v34 offset:31744
v_mfma_f32_16x16x32_bf16 v[84:87], v[156:159], a[56:59], v[84:87]
ds_read_b64_tr_b16 v[184:185], v35 offset:30720
v_add_f32 v229, 0x3727c5ac, v229
v_mfma_f32_16x16x32_bf16 v[108:111], v[156:159], a[120:123], v[108:111]
ds_read_b64_tr_b16 v[186:187], v35 offset:31744
s_waitcnt lgkmcnt(12)
v_mfma_f32_16x16x32_bf16 v[112:115], v[160:163], a[184:187], v[112:115]
ds_read_b64_tr_b16 v[188:189], v36 offset:30720
ds_read_b64_tr_b16 v[190:191], v36 offset:31744
v_add_f32 v233, 0x3727c5ac, v233
s_waitcnt vmcnt(0) lgkmcnt(10)
v_mfma_f32_16x16x32_bf16 v[64:67], v[164:167], a[60:63], v[64:67]
v_add_f32 v237, 0x3727c5ac, v237
v_mfma_f32_16x16x32_bf16 v[88:91], v[164:167], a[124:127], v[88:91]
v_mfma_f32_16x16x32_bf16 v[68:71], v[168:171], a[60:63], v[68:71]
v_rsq_f32 v229, v229
v_mfma_f32_16x16x32_bf16 v[92:95], v[168:171], a[124:127], v[92:95]
s_waitcnt lgkmcnt(6)
v_mfma_f32_16x16x32_bf16 v[72:75], v[172:175], a[60:63], v[72:75]
v_mfma_f32_16x16x32_bf16 v[96:99], v[172:175], a[124:127], v[96:99]
v_mfma_f32_16x16x32_bf16 v[76:79], v[176:179], a[60:63], v[76:79]
v_rsq_f32 v233, v233
v_mfma_f32_16x16x32_bf16 v[100:103], v[176:179], a[124:127], v[100:103]
s_waitcnt lgkmcnt(2)
v_mfma_f32_16x16x32_bf16 v[80:83], v[180:183], a[60:63], v[80:83]
v_mfma_f32_16x16x32_bf16 v[104:107], v[180:183], a[124:127], v[104:107]
v_mfma_f32_16x16x32_bf16 v[84:87], v[184:187], a[60:63], v[84:87]
v_rsq_f32 v237, v237
v_mfma_f32_16x16x32_bf16 v[108:111], v[184:187], a[124:127], v[108:111]
s_waitcnt lgkmcnt(0)
v_mfma_f32_16x16x32_bf16 v[112:115], v[188:191], a[188:191], v[112:115]
s_cmp_lg_u32 s39, 0
s_cbranch_scc1 Lpkb
s_cmp_lg_u32 s38, 0
s_cbranch_scc1 Lpoll1446x
s_mov_b32 s98, 0x40000
s_or_b32 s57, s44, s61
s_sub_u32 s58, 16, s61
Lpoll1446:
buffer_load_dwordx4 v[248:251], v39, s[24:27], 0 offen sc1
buffer_load_dwordx4 v[252:255], v39, s[24:27], 0 offen offset:16 sc1
Lpoll1446p:
s_sub_u32 s98, s98, 1
s_cbranch_scc1 Lend
s_waitcnt vmcnt(0)
v_subrev_u32 v248, s57, v248
v_xor_b32 v249, s45, v249
v_subrev_u32 v250, s57, v250
v_xor_b32 v251, s45, v251
v_max_u32 v248, v248, v250
v_or_b32 v249, v249, v251
v_subrev_u32 v252, s57, v252
v_xor_b32 v253, s45, v253
v_max_u32 v248, v248, v252
v_or_b32 v249, v249, v253
v_subrev_u32 v254, s57, v254
v_xor_b32 v255, s45, v255
v_max_u32 v248, v248, v254
v_or_b32 v249, v249, v255
v_cmp_gt_u32 vcc, s58, v248
v_cmp_eq_u32 s[2:3], 0, v249
s_nop 1
s_and_b64 vcc, vcc, s[2:3]
s_cmp_eq_u64 vcc, exec
s_cbranch_scc1 Lpoll1446x
s_sleep 6
s_branch Lpoll1446
Lpoll1446x:
s_waitcnt vmcnt(0) lgkmcnt(0)
s_barrier
s_branch Lpkd
Lpkb:
s_barrier
Lpkd:
s_cmp_lg_u32 s39, 0
s_cbranch_scc1 Lcf1
v_lshlrev_b32 v17, 4, v15
s_lshl_b32 s57, s38, 6
v_add_u32 v19, s57, v17
s_mov_b32 exec_lo, 0x10001
s_mov_b32 exec_hi, 0x10001
ds_write_b128 v19, a[200:203]
ds_write_b128 v19, a[204:207] offset:256
s_mov_b64 exec, -1
s_waitcnt lgkmcnt(0)
s_barrier
ds_read_b128 v[200:203], v17 offset:0
ds_read_b128 v[204:207], v17 offset:64
ds_read_b128 v[208:211], v17 offset:128
ds_read_b128 v[212:215], v17 offset:192
ds_read_b128 v[216:219], v17 offset:256
ds_read_b128 v[220:223], v17 offset:320
ds_read_b128 v[224:227], v19 offset:128
ds_read_b128 a[200:203], v17 offset:0
ds_read_b128 a[204:207], v17 offset:64
ds_read_b128 a[208:211], v17 offset:128
ds_read_b128 a[212:215], v17 offset:192
ds_read_b128 a[216:219], v17 offset:256
ds_read_b128 a[220:223], v17 offset:320
ds_read_b128 a[224:227], v19 offset:128
s_waitcnt lgkmcnt(0)
Lcf1:
v_pk_fma_f32 v[112:113], v[236:237], v[224:225], v[112:113] op_sel_hi:[0,1,1] neg_lo:[1,0,0] neg_hi:[1,0,0]
s_add_u32 m0, s47, 98304
s_add_u32 s40, s82, 0
buffer_load_dwordx4 v1, s[24:27], s40 offen offset:0 sc1 lds
v_pk_fma_f32 v[114:115], v[236:237], v[226:227], v[114:115] op_sel_hi:[0,1,1] neg_lo:[1,0,0] neg_hi:[1,0,0]
v_pk_mul_f32 v[112:113], v[112:113], v[236:237] op_sel:[0,1] op_sel_hi:[1,1]
v_pk_mul_f32 v[114:115], v[114:115], v[236:237] op_sel:[0,1] op_sel_hi:[1,1]
v_cvt_pk_bf16_f32 v144, v112, v113
v_cvt_pk_bf16_f32 v145, v114, v115
ds_write_b64 v38, v[144:145]
v_pk_fma_f32 v[96:97], v[232:233], v[208:209], v[96:97] op_sel_hi:[0,1,1] neg_lo:[1,0,0] neg_hi:[1,0,0]
buffer_load_dwordx4 v1, s[24:27], s40 offen offset:1024 sc1 lds
v_pk_fma_f32 v[98:99], v[232:233], v[210:211], v[98:99] op_sel_hi:[0,1,1] neg_lo:[1,0,0] neg_hi:[1,0,0]
v_pk_mul_f32 v[96:97], v[96:97], v[232:233] op_sel:[0,1] op_sel_hi:[1,1]
v_pk_mul_f32 v[98:99], v[98:99], v[232:233] op_sel:[0,1] op_sel_hi:[1,1]
v_cvt_pk_bf16_f32 v136, v96, v97
v_cvt_pk_bf16_f32 v137, v98, v99
ds_write_b64 v61, v[136:137] offset:2048
v_pk_fma_f32 v[100:101], v[232:233], v[212:213], v[100:101] op_sel_hi:[0,1,1] neg_lo:[1,0,0] neg_hi:[1,0,0]
buffer_load_dwordx4 v1, s[24:27], s40 offen offset:2048 sc1 lds
v_pk_fma_f32 v[102:103], v[232:233], v[214:215], v[102:103] op_sel_hi:[0,1,1] neg_lo:[1,0,0] neg_hi:[1,0,0]
v_pk_mul_f32 v[100:101], v[100:101], v[232:233] op_sel:[0,1] op_sel_hi:[1,1]
v_pk_mul_f32 v[102:103], v[102:103], v[232:233] op_sel:[0,1] op_sel_hi:[1,1]
v_cvt_pk_bf16_f32 v138, v100, v101
v_cvt_pk_bf16_f32 v139, v102, v103
ds_write_b64 v61, v[138:139] offset:2560
v_pk_fma_f32 v[104:105], v[232:233], v[216:217], v[104:105] op_sel_hi:[0,1,1] neg_lo:[1,0,0] neg_hi:[1,0,0]
v_pk_fma_f32 v[106:107], v[232:233], v[218:219], v[106:107] op_sel_hi:[0,1,1] neg_lo:[1,0,0] neg_hi:[1,0,0]
buffer_load_dwordx4 v1, s[24:27], s40 offen offset:3072 sc1 lds
v_pk_mul_f32 v[104:105], v[104:105], v[232:233] op_sel:[0,1] op_sel_hi:[1,1]
v_pk_mul_f32 v[106:107], v[106:107], v[232:233] op_sel:[0,1] op_sel_hi:[1,1]
v_cvt_pk_bf16_f32 v140, v104, v105
v_cvt_pk_bf16_f32 v141, v106, v107
ds_write_b64 v62, v[140:141] offset:11264
v_pk_fma_f32 v[108:109], v[232:233], v[220:221], v[108:109] op_sel_hi:[0,1,1] neg_lo:[1,0,0] neg_hi:[1,0,0]
v_pk_fma_f32 v[110:111], v[232:233], v[222:223], v[110:111] op_sel_hi:[0,1,1] neg_lo:[1,0,0] neg_hi:[1,0,0]
s_add_u32 m0, s47, 102400
s_add_u32 s40, s82, 4096
buffer_load_dwordx4 v1, s[24:27], s40 offen offset:0 sc1 lds
v_pk_mul_f32 v[108:109], v[108:109], v[232:233] op_sel:[0,1] op_sel_hi:[1,1]
v_pk_mul_f32 v[110:111], v[110:111], v[232:233] op_sel:[0,1] op_sel_hi:[1,1]
v_cvt_pk_bf16_f32 v142, v108, v109
v_cvt_pk_bf16_f32 v143, v110, v111
ds_write_b64 v62, v[142:143] offset:11776
v_pk_fma_f32 v[72:73], v[228:229], v[208:209], v[72:73] op_sel_hi:[0,1,1] neg_lo:[1,0,0] neg_hi:[1,0,0]
v_pk_fma_f32 v[74:75], v[228:229], v[210:211], v[74:75] op_sel_hi:[0,1,1] neg_lo:[1,0,0] neg_hi:[1,0,0]
buffer_load_dwordx4 v1, s[24:27], s40 offen offset:1024 sc1 lds
v_pk_mul_f32 v[72:73], v[72:73], v[228:229] op_sel:[0,1] op_sel_hi:[1,1]
v_pk_mul_f32 v[74:75], v[74:75], v[228:229] op_sel:[0,1] op_sel_hi:[1,1]
v_cvt_pk_bf16_f32 v124, v72, v73
v_cvt_pk_bf16_f32 v125, v74, v75
v_pk_fma_f32 v[76:77], v[228:229], v[212:213], v[76:77] op_sel_hi:[0,1,1] neg_lo:[1,0,0] neg_hi:[1,0,0]
v_pk_fma_f32 v[78:79], v[228:229], v[214:215], v[78:79] op_sel_hi:[0,1,1] neg_lo:[1,0,0] neg_hi:[1,0,0]
v_pk_mul_f32 v[76:77], v[76:77], v[228:229] op_sel:[0,1] op_sel_hi:[1,1]
v_pk_mul_f32 v[78:79], v[78:79], v[228:229] op_sel:[0,1] op_sel_hi:[1,1]
buffer_load_dwordx4 v1, s[24:27], s40 offen offset:2048 sc1 lds
v_cvt_pk_bf16_f32 v126, v76, v77
v_cvt_pk_bf16_f32 v127, v78, v79
v_pk_fma_f32 v[80:81], v[228:229], v[216:217], v[80:81] op_sel_hi:[0,1,1] neg_lo:[1,0,0] neg_hi:[1,0,0]
v_pk_fma_f32 v[82:83], v[228:229], v[218:219], v[82:83] op_sel_hi:[0,1,1] neg_lo:[1,0,0] neg_hi:[1,0,0]
v_pk_mul_f32 v[80:81], v[80:81], v[228:229] op_sel:[0,1] op_sel_hi:[1,1]
v_pk_mul_f32 v[82:83], v[82:83], v[228:229] op_sel:[0,1] op_sel_hi:[1,1]
v_cvt_pk_bf16_f32 v128, v80, v81
buffer_load_dwordx4 v1, s[24:27], s40 offen offset:3072 sc1 lds
v_cvt_pk_bf16_f32 v129, v82, v83
ds_write_b64 v62, v[128:129] offset:10240
v_pk_fma_f32 v[84:85], v[228:229], v[220:221], v[84:85] op_sel_hi:[0,1,1] neg_lo:[1,0,0] neg_hi:[1,0,0]
v_pk_fma_f32 v[86:87], v[228:229], v[222:223], v[86:87] op_sel_hi:[0,1,1] neg_lo:[1,0,0] neg_hi:[1,0,0]
v_pk_mul_f32 v[84:85], v[84:85], v[228:229] op_sel:[0,1] op_sel_hi:[1,1]
v_pk_mul_f32 v[86:87], v[86:87], v[228:229] op_sel:[0,1] op_sel_hi:[1,1]
v_cvt_pk_bf16_f32 v130, v84, v85
v_cvt_pk_bf16_f32 v131, v86, v87
s_add_u32 m0, s47, 106496
s_add_u32 s40, s82, 8192
buffer_load_dwordx4 v1, s[24:27], s40 offen offset:0 sc1 lds
ds_write_b64 v62, v[130:131] offset:10752
s_waitcnt lgkmcnt(0)
s_barrier
ds_read_b64 v[148:149], v61 offset:0
ds_read_b64_tr_b16 v[152:153], v63 offset:9216
ds_read_b64_tr_b16 v[154:155], v63 offset:10240
ds_read_b64_tr_b16 v[156:157], v63 offset:11264
buffer_load_dwordx4 v1, s[24:27], s40 offen offset:1024 sc1 lds
ds_read_b64 v[150:151], v61 offset:512
ds_read_b64_tr_b16 v[160:161], v63 offset:9728
ds_read_b64_tr_b16 v[162:163], v63 offset:10752
ds_read_b64_tr_b16 v[164:165], v63 offset:11776
v_pk_fma_f32 v[64:65], v[228:229], v[200:201], v[64:65] op_sel_hi:[0,1,1] neg_lo:[1,0,0] neg_hi:[1,0,0]
v_pk_fma_f32 v[66:67], v[228:229], v[202:203], v[66:67] op_sel_hi:[0,1,1] neg_lo:[1,0,0] neg_hi:[1,0,0]
v_pk_mul_f32 v[64:65], v[64:65], v[228:229] op_sel:[0,1] op_sel_hi:[1,1]
buffer_load_dwordx4 v1, s[24:27], s40 offen offset:2048 sc1 lds
v_pk_mul_f32 v[66:67], v[66:67], v[228:229] op_sel:[0,1] op_sel_hi:[1,1]
v_cvt_pk_bf16_f32 v120, v64, v65
v_cvt_pk_bf16_f32 v121, v66, v67
v_pk_fma_f32 v[68:69], v[228:229], v[204:205], v[68:69] op_sel_hi:[0,1,1] neg_lo:[1,0,0] neg_hi:[1,0,0]
v_pk_fma_f32 v[70:71], v[228:229], v[206:207], v[70:71] op_sel_hi:[0,1,1] neg_lo:[1,0,0] neg_hi:[1,0,0]
v_pk_mul_f32 v[68:69], v[68:69], v[228:229] op_sel:[0,1] op_sel_hi:[1,1]
v_pk_mul_f32 v[70:71], v[70:71], v[228:229] op_sel:[0,1] op_sel_hi:[1,1]
v_cvt_pk_bf16_f32 v122, v68, v69
buffer_load_dwordx4 v1, s[24:27], s40 offen offset:3072 sc1 lds
v_cvt_pk_bf16_f32 v123, v70, v71
v_pk_fma_f32 v[88:89], v[232:233], v[200:201], v[88:89] op_sel_hi:[0,1,1] neg_lo:[1,0,0] neg_hi:[1,0,0]
v_pk_fma_f32 v[90:91], v[232:233], v[202:203], v[90:91] op_sel_hi:[0,1,1] neg_lo:[1,0,0] neg_hi:[1,0,0]
v_pk_mul_f32 v[88:89], v[88:89], v[232:233] op_sel:[0,1] op_sel_hi:[1,1]
v_pk_mul_f32 v[90:91], v[90:91], v[232:233] op_sel:[0,1] op_sel_hi:[1,1]
v_cvt_pk_bf16_f32 v132, v88, v89
v_cvt_pk_bf16_f32 v133, v90, v91
s_add_u32 m0, s47, 110592
s_add_u32 s40, s82, 12288
buffer_load_dwordx4 v1, s[24:27], s40 offen offset:0 sc1 lds
v_pk_fma_f32 v[92:93], v[232:233], v[204:205], v[92:93] op_sel_hi:[0,1,1] neg_lo:[1,0,0] neg_hi:[1,0,0]
v_pk_fma_f32 v[94:95], v[232:233], v[206:207], v[94:95] op_sel_hi:[0,1,1] neg_lo:[1,0,0] neg_hi:[1,0,0]
v_pk_mul_f32 v[92:93], v[92:93], v[232:233] op_sel:[0,1] op_sel_hi:[1,1]
v_pk_mul_f32 v[94:95], v[94:95], v[232:233] op_sel:[0,1] op_sel_hi:[1,1]
v_cvt_pk_bf16_f32 v134, v92, v93
v_cvt_pk_bf16_f32 v135, v94, v95
v_mfma_f32_16x16x16_bf16 v[172:175], v[124:125], v[120:121], v[40:43]
buffer_load_dwordx4 v1, s[24:27], s40 offen offset:1024 sc1 lds
v_mfma_f32_16x16x16_bf16 v[188:191], v[126:127], v[122:123], v[40:43]
v_mfma_f32_16x16x16_bf16 v[204:207], v[136:137], v[132:133], v[40:43]
v_mfma_f32_16x16x16_bf16 v[220:223], v[138:139], v[134:135], v[40:43]
s_waitcnt lgkmcnt(0)
v_mfma_f32_16x16x16_bf16 v[216:219], v[126:127], v[134:135], v[44:47]
v_mfma_f32_16x16x16_bf16 v[200:203], v[124:125], v[132:133], v[44:47]
v_mfma_f32_16x16x16_bf16 v[184:187], v[150:151], v[122:123], v[48:51]
v_mfma_f32_16x16x16_bf16 v[168:171], v[148:149], v[120:121], v[48:51]
buffer_load_dwordx4 v1, s[24:27], s40 offen offset:2048 sc1 lds
s_nop 1
v_max3_f32 v224, v220, v221, v222
s_nop 0
v_max3_f32 v225, v223, v216, v217
v_max3_f32 v208, v204, v205, v206
v_max3_f32 v209, v207, v200, v201
v_max3_f32 v192, v188, v189, v190
v_max3_f32 v193, v191, v184, v185
v_max3_f32 v176, v172, v173, v174
buffer_load_dwordx4 v1, s[24:27], s40 offen offset:3072 sc1 lds
v_max3_f32 v177, v175, v168, v169
v_max3_f32 v224, v224, v218, v219
v_max3_f32 v208, v208, v202, v203
v_max3_f32 v192, v192, v186, v187
v_max3_f32 v176, v176, v170, v171
v_max_f32 v224, v224, v225
v_max_f32 v208, v208, v209
v_max_f32 v192, v192, v193
v_max_f32 v176, v176, v177
v_mov_b32 v225, v224
v_mov_b32 v209, v208
v_mov_b32 v193, v192
v_mov_b32 v177, v176
v_permlane16_swap_b32 v224, v225
v_permlane16_swap_b32 v208, v209
v_permlane16_swap_b32 v192, v193
v_permlane16_swap_b32 v176, v177
v_max_f32 v224, v224, v225
v_max_f32 v208, v208, v209
v_max_f32 v192, v192, v193
v_max_f32 v176, v176, v177
v_mov_b32 v225, v224
s_add_u32 m0, s49, 0
s_add_u32 s40, s68, 0
buffer_load_dwordx4 v1, s[24:27], s40 offen offset:0 sc1 lds
v_mov_b32 v209, v208
v_mov_b32 v193, v192
v_mov_b32 v177, v176
v_permlane32_swap_b32 v224, v225
v_permlane32_swap_b32 v208, v209
v_permlane32_swap_b32 v192, v193
v_permlane32_swap_b32 v176, v177
v_max_f32 v224, v224, v225
v_max_f32 v208, v208, v209
v_max_f32 v192, v192, v193
v_max_f32 v176, v176, v177
v_mov_b32 v20, 0x3eb8aa3b
buffer_load_dwordx4 v1, s[24:27], s40 offen offset:1024 sc1 lds
v_mul_f32 v224, v20, v224
v_mul_f32 v208, v20, v208
v_mul_f32 v192, v20, v192
v_mul_f32 v176, v20, v176
v_pk_fma_f32 v[216:217], v[216:217], v[20:21], v[224:225] op_sel_hi:[1,0,0] neg_lo:[0,0,1] neg_hi:[0,0,1]
v_pk_fma_f32 v[218:219], v[218:219], v[20:21], v[224:225] op_sel_hi:[1,0,0] neg_lo:[0,0,1] neg_hi:[0,0,1]
v_pk_fma_f32 v[220:221], v[220:221], v[20:21], v[224:225] op_sel_hi:[1,0,0] neg_lo:[0,0,1] neg_hi:[0,0,1]
v_pk_fma_f32 v[222:223], v[222:223], v[20:21], v[224:225] op_sel_hi:[1,0,0] neg_lo:[0,0,1] neg_hi:[0,0,1]
v_exp_f32 v216, v216
v_exp_f32 v217, v217
v_exp_f32 v218, v218
v_exp_f32 v219, v219
buffer_load_dwordx4 v1, s[24:27], s40 offen offset:2048 sc1 lds
v_exp_f32 v220, v220
v_exp_f32 v221, v221
v_exp_f32 v222, v222
v_exp_f32 v223, v223
v_pk_fma_f32 v[200:201], v[200:201], v[20:21], v[208:209] op_sel_hi:[1,0,0] neg_lo:[0,0,1] neg_hi:[0,0,1]
v_pk_fma_f32 v[202:203], v[202:203], v[20:21], v[208:209] op_sel_hi:[1,0,0] neg_lo:[0,0,1] neg_hi:[0,0,1]
v_pk_fma_f32 v[204:205], v[204:205], v[20:21], v[208:209] op_sel_hi:[1,0,0] neg_lo:[0,0,1] neg_hi:[0,0,1]
v_pk_fma_f32 v[206:207], v[206:207], v[20:21], v[208:209] op_sel_hi:[1,0,0] neg_lo:[0,0,1] neg_hi:[0,0,1]
v_exp_f32 v200, v200
v_exp_f32 v201, v201
v_exp_f32 v202, v202
v_exp_f32 v203, v203
v_exp_f32 v204, v204
buffer_load_dwordx4 v1, s[24:27], s40 offen offset:3072 sc1 lds
v_exp_f32 v205, v205
v_exp_f32 v206, v206
v_exp_f32 v207, v207
v_pk_fma_f32 v[184:185], v[184:185], v[20:21], v[192:193] op_sel_hi:[1,0,0] neg_lo:[0,0,1] neg_hi:[0,0,1]
v_pk_fma_f32 v[186:187], v[186:187], v[20:21], v[192:193] op_sel_hi:[1,0,0] neg_lo:[0,0,1] neg_hi:[0,0,1]
v_pk_fma_f32 v[188:189], v[188:189], v[20:21], v[192:193] op_sel_hi:[1,0,0] neg_lo:[0,0,1] neg_hi:[0,0,1]
v_pk_fma_f32 v[190:191], v[190:191], v[20:21], v[192:193] op_sel_hi:[1,0,0] neg_lo:[0,0,1] neg_hi:[0,0,1]
v_exp_f32 v184, v184
v_exp_f32 v185, v185
v_exp_f32 v186, v186
v_exp_f32 v187, v187
v_exp_f32 v188, v188
s_add_u32 m0, s49, 4096
s_add_u32 s40, s68, 4096
buffer_load_dwordx4 v1, s[24:27], s40 offen offset:0 sc1 lds
v_exp_f32 v189, v189
v_exp_f32 v190, v190
v_exp_f32 v191, v191
v_pk_fma_f32 v[168:169], v[168:169], v[20:21], v[176:177] op_sel_hi:[1,0,0] neg_lo:[0,0,1] neg_hi:[0,0,1]
v_pk_fma_f32 v[170:171], v[170:171], v[20:21], v[176:177] op_sel_hi:[1,0,0] neg_lo:[0,0,1] neg_hi:[0,0,1]
v_pk_fma_f32 v[172:173], v[172:173], v[20:21], v[176:177] op_sel_hi:[1,0,0] neg_lo:[0,0,1] neg_hi:[0,0,1]
v_pk_fma_f32 v[174:175], v[174:175], v[20:21], v[176:177] op_sel_hi:[1,0,0] neg_lo:[0,0,1] neg_hi:[0,0,1]
v_exp_f32 v168, v168
v_exp_f32 v169, v169
v_exp_f32 v170, v170
v_exp_f32 v171, v171
v_exp_f32 v172, v172
v_exp_f32 v173, v173
buffer_load_dwordx4 v1, s[24:27], s40 offen offset:1024 sc1 lds
v_exp_f32 v174, v174
v_exp_f32 v175, v175
v_cvt_pk_bf16_f32 v228, v216, v217
v_cvt_pk_bf16_f32 v229, v218, v219
v_cvt_pk_bf16_f32 v230, v220, v221
v_cvt_pk_bf16_f32 v231, v222, v223
v_cvt_pk_bf16_f32 v212, v200, v201
v_cvt_pk_bf16_f32 v213, v202, v203
v_cvt_pk_bf16_f32 v214, v204, v205
v_cvt_pk_bf16_f32 v215, v206, v207
v_cvt_pk_bf16_f32 v196, v184, v185
v_cvt_pk_bf16_f32 v197, v186, v187
buffer_load_dwordx4 v1, s[24:27], s40 offen offset:2048 sc1 lds
v_cvt_pk_bf16_f32 v198, v188, v189
v_cvt_pk_bf16_f32 v199, v190, v191
v_cvt_pk_bf16_f32 v180, v168, v169
v_cvt_pk_bf16_f32 v181, v170, v171
v_cvt_pk_bf16_f32 v182, v172, v173
v_cvt_pk_bf16_f32 v183, v174, v175
v_mfma_f32_16x16x32_bf16 v[216:219], v[162:165], v[228:231], 0
v_mfma_f32_16x16x32_bf16 v[220:223], v[28:31], v[228:231], 0
v_mfma_f32_16x16x32_bf16 v[200:203], v[154:157], v[212:215], 0
v_mfma_f32_16x16x32_bf16 v[204:207], v[28:31], v[212:215], 0
v_mfma_f32_16x16x32_bf16 v[184:187], v[160:163], v[196:199], 0
v_mfma_f32_16x16x32_bf16 v[188:191], v[28:31], v[196:199], 0
v_mfma_f32_16x16x32_bf16 v[168:171], v[152:155], v[180:183], 0
v_mfma_f32_16x16x32_bf16 v[172:175], v[28:31], v[180:183], 0
s_nop 1
v_rcp_f32 v220, v220
s_nop 0
v_rcp_f32 v204, v204
s_nop 0
v_rcp_f32 v188, v188
s_nop 0
v_rcp_f32 v172, v172
v_pk_mul_f32 v[216:217], v[216:217], v[220:221] op_sel_hi:[1,0]
v_pk_mul_f32 v[218:219], v[218:219], v[220:221] op_sel_hi:[1,0]
v_pk_mul_f32 v[200:201], v[200:201], v[204:205] op_sel_hi:[1,0]
v_pk_mul_f32 v[202:203], v[202:203], v[204:205] op_sel_hi:[1,0]
v_pk_mul_f32 v[184:185], v[184:185], v[188:189] op_sel_hi:[1,0]
v_pk_mul_f32 v[186:187], v[186:187], v[188:189] op_sel_hi:[1,0]
v_pk_mul_f32 v[168:169], v[168:169], v[172:173] op_sel_hi:[1,0]
v_pk_mul_f32 v[170:171], v[170:171], v[172:173] op_sel_hi:[1,0]
v_cvt_pk_bf16_f32 v102, v216, v217
v_cvt_pk_bf16_f32 v103, v218, v219
v_cvt_pk_bf16_f32 v100, v200, v201
v_cvt_pk_bf16_f32 v101, v202, v203
v_cvt_pk_bf16_f32 v98, v184, v185
v_cvt_pk_bf16_f32 v99, v186, v187
v_cvt_pk_bf16_f32 v96, v168, v169
v_cvt_pk_bf16_f32 v97, v170, v171
s_lshl_b32 s58, s37, 10
s_add_u32 s57, s43, s58
s_add_u32 s57, s57, s60
s_add_u32 s58, s57, 0x4000
buffer_store_dwordx4 v[100:103], v1, s[24:27], s58 offen sc1
buffer_store_dwordx4 v[96:99], v1, s[24:27], s57 offen sc1
s_add_u32 m0, s49, 28672
s_add_u32 s40, s69, 0
buffer_load_dwordx4 v1, s[24:27], s40 offen offset:0 sc1 lds
buffer_load_dwordx4 v1, s[24:27], s40 offen offset:1024 sc1 lds
buffer_load_dwordx4 v1, s[24:27], s40 offen offset:2048 sc1 lds
buffer_load_dwordx4 v1, s[24:27], s40 offen offset:3072 sc1 lds
s_add_u32 m0, s49, 32768
s_add_u32 s40, s69, 4096
buffer_load_dwordx4 v1, s[24:27], s40 offen offset:0 sc1 lds
buffer_load_dwordx4 v1, s[24:27], s40 offen offset:1024 sc1 lds
buffer_load_dwordx4 v1, s[24:27], s40 offen offset:2048 sc1 lds
s_add_u32 s61, s61, 1
s_or_b32 s57, s44, s61
v_mov_b32 v22, s57
v_mov_b32 v23, s45
s_lshl_b32 s58, s37, 3
s_cmp_lg_u32 s38, 0
s_waitcnt vmcnt(7)
s_barrier
s_cbranch_scc1 Lsig1807
s_mov_b64 exec, 1
buffer_store_dwordx2 v[22:23], v12, s[24:27], s58 offen sc1
s_mov_b64 exec, -1
Lsig1807:
s_add_u32 m0, s49, 57344
s_add_u32 s40, s70, 0
buffer_load_dwordx4 v1, s[24:27], s40 offen offset:0 sc1 lds
buffer_load_dwordx4 v1, s[24:27], s40 offen offset:1024 sc1 lds
buffer_load_dwordx4 v1, s[24:27], s40 offen offset:2048 sc1 lds
buffer_load_dwordx4 v1, s[24:27], s40 offen offset:3072 sc1 lds
s_add_u32 m0, s49, 61440
s_add_u32 s40, s70, 4096
buffer_load_dwordx4 v1, s[24:27], s40 offen offset:0 sc1 lds
buffer_load_dwordx4 v1, s[24:27], s40 offen offset:1024 sc1 lds
buffer_load_dwordx4 v1, s[24:27], s40 offen offset:2048 sc1 lds
s_mov_b32 s59, 98304
v_lshrrev_b32 v17, 1, v14
v_and_b32 v17, 3, v17
v_lshl_add_u32 v18, v14, 7, v16
v_add_u32 v18, s59, v18
v_xor_b32 v32, 0, v17
v_lshl_add_u32 v32, v32, 5, v18
v_xor_b32 v33, 1, v17
v_lshl_add_u32 v33, v33, 5, v18
v_xor_b32 v34, 2, v17
v_lshl_add_u32 v34, v34, 5, v18
v_xor_b32 v35, 3, v17
v_lshl_add_u32 v35, v35, 5, v18
s_add_u32 s57, s42, s60
v_add_u32 v24, s57, v1
ds_read_b64_tr_b16 a[64:65], v32 offset:0
ds_read_b64_tr_b16 a[66:67], v32 offset:2048
ds_read_b64_tr_b16 a[68:69], v33 offset:0
ds_read_b64_tr_b16 a[70:71], v33 offset:2048
ds_read_b64_tr_b16 a[72:73], v34 offset:0
ds_read_b64_tr_b16 a[74:75], v34 offset:2048
ds_read_b64_tr_b16 a[76:77], v35 offset:0
ds_read_b64_tr_b16 a[78:79], v35 offset:2048
ds_read_b64_tr_b16 a[80:81], v32 offset:4096
ds_read_b64_tr_b16 a[82:83], v32 offset:6144
ds_read_b64_tr_b16 a[84:85], v33 offset:4096
ds_read_b64_tr_b16 a[86:87], v33 offset:6144
ds_read_b64_tr_b16 a[88:89], v34 offset:4096
ds_read_b64_tr_b16 a[90:91], v34 offset:6144
ds_read_b64_tr_b16 a[92:93], v35 offset:4096
ds_read_b64_tr_b16 a[94:95], v35 offset:6144
ds_read_b64_tr_b16 a[96:97], v32 offset:8192
ds_read_b64_tr_b16 a[98:99], v32 offset:10240
ds_read_b64_tr_b16 a[100:101], v33 offset:8192
ds_read_b64_tr_b16 a[102:103], v33 offset:10240
ds_read_b64_tr_b16 a[104:105], v34 offset:8192
ds_read_b64_tr_b16 a[106:107], v34 offset:10240
ds_read_b64_tr_b16 a[108:109], v35 offset:8192
ds_read_b64_tr_b16 a[110:111], v35 offset:10240
ds_read_b64_tr_b16 a[112:113], v32 offset:12288
ds_read_b64_tr_b16 a[114:115], v32 offset:14336
ds_read_b64_tr_b16 a[116:117], v33 offset:12288
ds_read_b64_tr_b16 a[118:119], v33 offset:14336
ds_read_b64_tr_b16 a[120:121], v34 offset:12288
ds_read_b64_tr_b16 a[122:123], v34 offset:14336
ds_read_b64_tr_b16 a[124:125], v35 offset:12288
ds_read_b64_tr_b16 a[126:127], v35 offset:14336
ds_read_b64_tr_b16 a[128:129], v32 offset:16384
ds_read_b64_tr_b16 a[130:131], v32 offset:18432
ds_read_b64_tr_b16 a[132:133], v33 offset:16384
ds_read_b64_tr_b16 a[134:135], v33 offset:18432
ds_read_b64_tr_b16 a[136:137], v34 offset:16384
ds_read_b64_tr_b16 a[138:139], v34 offset:18432
ds_read_b64_tr_b16 a[140:141], v35 offset:16384
ds_read_b64_tr_b16 a[142:143], v35 offset:18432
ds_read_b64_tr_b16 a[144:145], v32 offset:20480
ds_read_b64_tr_b16 a[146:147], v32 offset:22528
ds_read_b64_tr_b16 a[148:149], v33 offset:20480
ds_read_b64_tr_b16 a[150:151], v33 offset:22528
ds_read_b64_tr_b16 a[152:153], v34 offset:20480
ds_read_b64_tr_b16 a[154:155], v34 offset:22528
ds_read_b64_tr_b16 a[156:157], v35 offset:20480
ds_read_b64_tr_b16 a[158:159], v35 offset:22528
ds_read_b64_tr_b16 a[160:161], v32 offset:24576
ds_read_b64_tr_b16 a[162:163], v32 offset:26624
ds_read_b64_tr_b16 a[164:165], v33 offset:24576
ds_read_b64_tr_b16 a[166:167], v33 offset:26624
ds_read_b64_tr_b16 a[168:169], v34 offset:24576
ds_read_b64_tr_b16 a[170:171], v34 offset:26624
ds_read_b64_tr_b16 a[172:173], v35 offset:24576
ds_read_b64_tr_b16 a[174:175], v35 offset:26624
ds_read_b64_tr_b16 a[176:177], v32 offset:28672
ds_read_b64_tr_b16 a[178:179], v32 offset:30720
ds_read_b64_tr_b16 a[180:181], v33 offset:28672
ds_read_b64_tr_b16 a[182:183], v33 offset:30720
ds_read_b64_tr_b16 a[184:185], v34 offset:28672
ds_read_b64_tr_b16 a[186:187], v34 offset:30720
ds_read_b64_tr_b16 a[188:189], v35 offset:28672
ds_read_b64_tr_b16 a[190:191], v35 offset:30720
ds_read_b64_tr_b16 v[112:113], v32 offset:32768
ds_read_b64_tr_b16 v[114:115], v32 offset:34816
ds_read_b64_tr_b16 v[116:117], v33 offset:32768
ds_read_b64_tr_b16 v[118:119], v33 offset:34816
ds_read_b64_tr_b16 v[120:121], v34 offset:32768
ds_read_b64_tr_b16 v[122:123], v34 offset:34816
ds_read_b64_tr_b16 v[124:125], v35 offset:32768
ds_read_b64_tr_b16 v[126:127], v35 offset:34816
ds_read_b64_tr_b16 v[128:129], v32 offset:36864
ds_read_b64_tr_b16 v[130:131], v32 offset:38912
ds_read_b64_tr_b16 v[132:133], v33 offset:36864
ds_read_b64_tr_b16 v[134:135], v33 offset:38912
ds_read_b64_tr_b16 v[136:137], v34 offset:36864
ds_read_b64_tr_b16 v[138:139], v34 offset:38912
ds_read_b64_tr_b16 v[140:141], v35 offset:36864
ds_read_b64_tr_b16 v[142:143], v35 offset:38912
ds_read_b64_tr_b16 v[144:145], v32 offset:40960
ds_read_b64_tr_b16 v[146:147], v32 offset:43008
ds_read_b64_tr_b16 v[148:149], v33 offset:40960
ds_read_b64_tr_b16 v[150:151], v33 offset:43008
ds_read_b64_tr_b16 v[152:153], v34 offset:40960
ds_read_b64_tr_b16 v[154:155], v34 offset:43008
ds_read_b64_tr_b16 v[156:157], v35 offset:40960
ds_read_b64_tr_b16 v[158:159], v35 offset:43008
ds_read_b64_tr_b16 v[160:161], v32 offset:45056
ds_read_b64_tr_b16 v[162:163], v32 offset:47104
ds_read_b64_tr_b16 v[164:165], v33 offset:45056
ds_read_b64_tr_b16 v[166:167], v33 offset:47104
ds_read_b64_tr_b16 v[168:169], v34 offset:45056
ds_read_b64_tr_b16 v[170:171], v34 offset:47104
ds_read_b64_tr_b16 v[172:173], v35 offset:45056
ds_read_b64_tr_b16 v[174:175], v35 offset:47104
ds_read_b64_tr_b16 v[176:177], v32 offset:49152
ds_read_b64_tr_b16 v[178:179], v32 offset:51200
ds_read_b64_tr_b16 v[180:181], v33 offset:49152
ds_read_b64_tr_b16 v[182:183], v33 offset:51200
ds_read_b64_tr_b16 v[184:185], v34 offset:49152
ds_read_b64_tr_b16 v[186:187], v34 offset:51200
ds_read_b64_tr_b16 v[188:189], v35 offset:49152
ds_read_b64_tr_b16 v[190:191], v35 offset:51200
ds_read_b64_tr_b16 v[192:193], v32 offset:53248
ds_read_b64_tr_b16 v[194:195], v32 offset:55296
ds_read_b64_tr_b16 v[196:197], v33 offset:53248
ds_read_b64_tr_b16 v[198:199], v33 offset:55296
ds_read_b64_tr_b16 v[200:201], v34 offset:53248
ds_read_b64_tr_b16 v[202:203], v34 offset:55296
ds_read_b64_tr_b16 v[204:205], v35 offset:53248
ds_read_b64_tr_b16 v[206:207], v35 offset:55296
ds_read_b64_tr_b16 v[208:209], v32 offset:57344
ds_read_b64_tr_b16 v[210:211], v32 offset:59392
ds_read_b64_tr_b16 v[212:213], v33 offset:57344
ds_read_b64_tr_b16 v[214:215], v33 offset:59392
ds_read_b64_tr_b16 v[216:217], v34 offset:57344
ds_read_b64_tr_b16 v[218:219], v34 offset:59392
ds_read_b64_tr_b16 v[220:221], v35 offset:57344
ds_read_b64_tr_b16 v[222:223], v35 offset:59392
ds_read_b64_tr_b16 v[224:225], v32 offset:61440
ds_read_b64_tr_b16 v[226:227], v32 offset:63488
ds_read_b64_tr_b16 v[228:229], v33 offset:61440
ds_read_b64_tr_b16 v[230:231], v33 offset:63488
ds_read_b64_tr_b16 v[232:233], v34 offset:61440
ds_read_b64_tr_b16 v[234:235], v34 offset:63488
ds_read_b64_tr_b16 v[236:237], v35 offset:61440
ds_read_b64_tr_b16 v[238:239], v35 offset:63488
s_cmp_lg_u32 s38, 0
s_cbranch_scc1 Lpoll1974x
s_mov_b32 s98, 0x40000
s_or_b32 s57, s44, s61
s_sub_u32 s58, 16, s61
Lpoll1974:
buffer_load_dwordx2 v[248:249], v12, s[24:27], 0 offen sc1
Lpoll1974p:
s_sub_u32 s98, s98, 1
s_cbranch_scc1 Lend
s_waitcnt vmcnt(0)
v_subrev_u32 v248, s57, v248
v_xor_b32 v249, s45, v249
v_cmp_gt_u32 vcc, s58, v248
v_cmp_eq_u32 s[2:3], 0, v249
s_nop 1
s_and_b64 vcc, vcc, s[2:3]
s_cmp_eq_u64 vcc, exec
s_cbranch_scc1 Lpoll1974x
s_sleep 6
s_branch Lpoll1974
Lpoll1974x:
s_waitcnt vmcnt(0) lgkmcnt(0)
s_barrier
buffer_load_dwordx4 a[0:3], v24, s[24:27], s64 offen offset:0 sc1
buffer_load_dwordx4 a[4:7], v24, s[24:27], s64 offen offset:1024 sc1
buffer_load_dwordx4 a[8:11], v24, s[24:27], s64 offen offset:2048 sc1
buffer_load_dwordx4 a[12:15], v24, s[24:27], s64 offen offset:3072 sc1
buffer_load_dwordx4 a[16:19], v24, s[24:27], s65 offen offset:0 sc1
buffer_load_dwordx4 a[20:23], v24, s[24:27], s65 offen offset:1024 sc1
buffer_load_dwordx4 a[24:27], v24, s[24:27], s65 offen offset:2048 sc1
buffer_load_dwordx4 a[28:31], v24, s[24:27], s65 offen offset:3072 sc1
buffer_load_dwordx4 a[32:35], v24, s[24:27], s66 offen offset:0 sc1
buffer_load_dwordx4 a[36:39], v24, s[24:27], s66 offen offset:1024 sc1
buffer_load_dwordx4 a[40:43], v24, s[24:27], s66 offen offset:2048 sc1
buffer_load_dwordx4 a[44:47], v24, s[24:27], s66 offen offset:3072 sc1
s_waitcnt vmcnt(11)
v_mfma_f32_16x16x32_bf16 v[64:67], a[64:67], a[0:3], 0
buffer_load_dwordx4 a[48:51], v24, s[24:27], s67 offen offset:0 sc1
v_mfma_f32_16x16x32_bf16 v[68:71], a[68:71], a[0:3], 0
v_mfma_f32_16x16x32_bf16 v[72:75], a[72:75], a[0:3], 0
v_mfma_f32_16x16x32_bf16 v[76:79], a[76:79], a[0:3], 0
s_waitcnt vmcnt(11)
v_mfma_f32_16x16x32_bf16 v[64:67], a[80:83], a[4:7], v[64:67]
buffer_load_dwordx4 a[52:55], v24, s[24:27], s67 offen offset:1024 sc1
v_mfma_f32_16x16x32_bf16 v[68:71], a[84:87], a[4:7], v[68:71]
v_mfma_f32_16x16x32_bf16 v[72:75], a[88:91], a[4:7], v[72:75]
v_mfma_f32_16x16x32_bf16 v[76:79], a[92:95], a[4:7], v[76:79]
s_waitcnt vmcnt(11)
v_mfma_f32_16x16x32_bf16 v[64:67], a[96:99], a[8:11], v[64:67]
buffer_load_dwordx4 a[56:59], v24, s[24:27], s67 offen offset:2048 sc1
v_mfma_f32_16x16x32_bf16 v[68:71], a[100:103], a[8:11], v[68:71]
v_mfma_f32_16x16x32_bf16 v[72:75], a[104:107], a[8:11], v[72:75]
v_mfma_f32_16x16x32_bf16 v[76:79], a[108:111], a[8:11], v[76:79]
s_waitcnt vmcnt(11)
v_mfma_f32_16x16x32_bf16 v[64:67], a[112:115], a[12:15], v[64:67]
buffer_load_dwordx4 a[60:63], v24, s[24:27], s67 offen offset:3072 sc1
v_mfma_f32_16x16x32_bf16 v[68:71], a[116:119], a[12:15], v[68:71]
v_mfma_f32_16x16x32_bf16 v[72:75], a[120:123], a[12:15], v[72:75]
v_mfma_f32_16x16x32_bf16 v[76:79], a[124:127], a[12:15], v[76:79]
s_waitcnt vmcnt(11)
v_mfma_f32_16x16x32_bf16 v[64:67], a[128:131], a[16:19], v[64:67]
v_mfma_f32_16x16x32_bf16 v[68:71], a[132:135], a[16:19], v[68:71]
v_mfma_f32_16x16x32_bf16 v[72:75], a[136:139], a[16:19], v[72:75]
v_mfma_f32_16x16x32_bf16 v[76:79], a[140:143], a[16:19], v[76:79]
s_waitcnt vmcnt(10)
v_mfma_f32_16x16x32_bf16 v[64:67], a[144:147], a[20:23], v[64:67]
v_mfma_f32_16x16x32_bf16 v[68:71], a[148:151], a[20:23], v[68:71]
v_mfma_f32_16x16x32_bf16 v[72:75], a[152:155], a[20:23], v[72:75]
v_mfma_f32_16x16x32_bf16 v[76:79], a[156:159], a[20:23], v[76:79]
s_waitcnt vmcnt(9)
v_mfma_f32_16x16x32_bf16 v[64:67], a[160:163], a[24:27], v[64:67]
v_mfma_f32_16x16x32_bf16 v[68:71], a[164:167], a[24:27], v[68:71]
v_mfma_f32_16x16x32_bf16 v[72:75], a[168:171], a[24:27], v[72:75]
v_mfma_f32_16x16x32_bf16 v[76:79], a[172:175], a[24:27], v[76:79]
s_waitcnt vmcnt(8)
v_mfma_f32_16x16x32_bf16 v[64:67], a[176:179], a[28:31], v[64:67]
v_mfma_f32_16x16x32_bf16 v[68:71], a[180:183], a[28:31], v[68:71]
v_mfma_f32_16x16x32_bf16 v[72:75], a[184:187], a[28:31], v[72:75]
v_mfma_f32_16x16x32_bf16 v[76:79], a[188:191], a[28:31], v[76:79]
s_waitcnt vmcnt(7)
v_mfma_f32_16x16x32_bf16 v[64:67], v[112:115], a[32:35], v[64:67]
v_mfma_f32_16x16x32_bf16 v[68:71], v[116:119], a[32:35], v[68:71]
v_mfma_f32_16x16x32_bf16 v[72:75], v[120:123], a[32:35], v[72:75]
v_mfma_f32_16x16x32_bf16 v[76:79], v[124:127], a[32:35], v[76:79]
s_waitcnt vmcnt(6)
v_mfma_f32_16x16x32_bf16 v[64:67], v[128:131], a[36:39], v[64:67]
s_add_u32 m0, s49, 86016
s_add_u32 s40, s71, 0
buffer_load_dwordx4 v1, s[24:27], s40 offen offset:0 sc1 lds
v_mfma_f32_16x16x32_bf16 v[68:71], v[132:135], a[36:39], v[68:71]
v_mfma_f32_16x16x32_bf16 v[72:75], v[136:139], a[36:39], v[72:75]
v_mfma_f32_16x16x32_bf16 v[76:79], v[140:143], a[36:39], v[76:79]
s_waitcnt vmcnt(6)
v_mfma_f32_16x16x32_bf16 v[64:67], v[144:147], a[40:43], v[64:67]
buffer_load_dwordx4 v1, s[24:27], s40 offen offset:1024 sc1 lds
v_mfma_f32_16x16x32_bf16 v[68:71], v[148:151], a[40:43], v[68:71]
v_mfma_f32_16x16x32_bf16 v[72:75], v[152:155], a[40:43], v[72:75]
v_mfma_f32_16x16x32_bf16 v[76:79], v[156:159], a[40:43], v[76:79]
s_waitcnt vmcnt(6)
v_mfma_f32_16x16x32_bf16 v[64:67], v[160:163], a[44:47], v[64:67]
buffer_load_dwordx4 v1, s[24:27], s40 offen offset:2048 sc1 lds
v_mfma_f32_16x16x32_bf16 v[68:71], v[164:167], a[44:47], v[68:71]
v_mfma_f32_16x16x32_bf16 v[72:75], v[168:171], a[44:47], v[72:75]
v_mfma_f32_16x16x32_bf16 v[76:79], v[172:175], a[44:47], v[76:79]
s_waitcnt vmcnt(6)
v_mfma_f32_16x16x32_bf16 v[64:67], v[176:179], a[48:51], v[64:67]
buffer_load_dwordx4 v1, s[24:27], s40 offen offset:3072 sc1 lds
v_mfma_f32_16x16x32_bf16 v[68:71], v[180:183], a[48:51], v[68:71]
v_mfma_f32_16x16x32_bf16 v[72:75], v[184:187], a[48:51], v[72:75]
v_mfma_f32_16x16x32_bf16 v[76:79], v[188:191], a[48:51], v[76:79]
s_waitcnt vmcnt(6)
v_mfma_f32_16x16x32_bf16 v[64:67], v[192:195], a[52:55], v[64:67]
s_add_u32 m0, s49, 90112
s_add_u32 s40, s71, 4096
buffer_load_dwordx4 v1, s[24:27], s40 offen offset:0 sc1 lds
v_mfma_f32_16x16x32_bf16 v[68:71], v[196:199], a[52:55], v[68:71]
v_mfma_f32_16x16x32_bf16 v[72:75], v[200:203], a[52:55], v[72:75]
v_mfma_f32_16x16x32_bf16 v[76:79], v[204:207], a[52:55], v[76:79]
s_waitcnt vmcnt(6)
v_mfma_f32_16x16x32_bf16 v[64:67], v[208:211], a[56:59], v[64:67]
buffer_load_dwordx4 v1, s[24:27], s40 offen offset:1024 sc1 lds
v_mfma_f32_16x16x32_bf16 v[68:71], v[212:215], a[56:59], v[68:71]
v_mfma_f32_16x16x32_bf16 v[72:75], v[216:219], a[56:59], v[72:75]
v_mfma_f32_16x16x32_bf16 v[76:79], v[220:223], a[56:59], v[76:79]
s_waitcnt vmcnt(6)
v_mfma_f32_16x16x32_bf16 v[64:67], v[224:227], a[60:63], v[64:67]
buffer_load_dwordx4 v1, s[24:27], s40 offen offset:2048 sc1 lds
v_mfma_f32_16x16x32_bf16 v[68:71], v[228:231], a[60:63], v[68:71]
v_mfma_f32_16x16x32_bf16 v[72:75], v[232:235], a[60:63], v[72:75]
v_mfma_f32_16x16x32_bf16 v[76:79], v[236:239], a[60:63], v[76:79]
v_lshlrev_b32 v96, 16, v2
v_and_b32 v97, 0xffff0000, v2
s_nop 1
v_pk_add_f32 v[96:97], v[96:97], v[64:65]
v_cvt_pk_bf16_f32 v2, v96, v97
v_lshlrev_b32 v98, 16, v3
v_and_b32 v99, 0xffff0000, v3
v_pk_add_f32 v[98:99], v[98:99], v[66:67]
v_cvt_pk_bf16_f32 v3, v98, v99
v_lshlrev_b32 v100, 16, v4
v_and_b32 v101, 0xffff0000, v4
v_pk_add_f32 v[100:101], v[100:101], v[68:69]
v_cvt_pk_bf16_f32 v4, v100, v101
v_lshlrev_b32 v102, 16, v5
v_and_b32 v103, 0xffff0000, v5
v_pk_add_f32 v[102:103], v[102:103], v[70:71]
v_cvt_pk_bf16_f32 v5, v102, v103
v_lshlrev_b32 v104, 16, v6
v_and_b32 v105, 0xffff0000, v6
v_pk_add_f32 v[104:105], v[104:105], v[72:73]
v_cvt_pk_bf16_f32 v6, v104, v105
v_lshlrev_b32 v106, 16, v7
v_and_b32 v107, 0xffff0000, v7
v_pk_add_f32 v[106:107], v[106:107], v[74:75]
v_cvt_pk_bf16_f32 v7, v106, v107
v_lshlrev_b32 v108, 16, v8
v_and_b32 v109, 0xffff0000, v8
v_pk_add_f32 v[108:109], v[108:109], v[76:77]
v_cvt_pk_bf16_f32 v8, v108, v109
v_lshlrev_b32 v110, 16, v9
v_and_b32 v111, 0xffff0000, v9
v_pk_add_f32 v[110:111], v[110:111], v[78:79]
v_cvt_pk_bf16_f32 v9, v110, v111
s_lshl_b32 s58, s63, 11
s_add_u32 s58, s58, s42
s_add_u32 s58, s58, s60
s_add_u32 s53, s58, 2097152
buffer_store_dwordx4 v[2:5], v1, s[24:27], s53 offen offset:0 sc1
buffer_store_dwordx4 v[6:9], v1, s[24:27], s53 offen offset:1024 sc1
v_pk_mul_f32 v[20:21], v[96:97], v[96:97]
v_pk_fma_f32 v[20:21], v[98:99], v[98:99], v[20:21]
v_pk_add_f32 v[96:97], v[96:97], v[98:99]
v_pk_fma_f32 v[20:21], v[100:101], v[100:101], v[20:21]
v_pk_add_f32 v[96:97], v[96:97], v[100:101]
v_pk_fma_f32 v[20:21], v[102:103], v[102:103], v[20:21]
v_pk_add_f32 v[96:97], v[96:97], v[102:103]
v_pk_fma_f32 v[20:21], v[104:105], v[104:105], v[20:21]
v_pk_add_f32 v[96:97], v[96:97], v[104:105]
v_pk_fma_f32 v[20:21], v[106:107], v[106:107], v[20:21]
v_pk_add_f32 v[96:97], v[96:97], v[106:107]
v_pk_fma_f32 v[20:21], v[108:109], v[108:109], v[20:21]
v_pk_add_f32 v[96:97], v[96:97], v[108:109]
v_pk_fma_f32 v[20:21], v[110:111], v[110:111], v[20:21]
v_pk_add_f32 v[96:97], v[96:97], v[110:111]
v_add_f32 v21, v20, v21
v_add_f32 v20, v96, v97
v_mov_b32 v17, v20
s_nop 1
v_permlane16_swap_b32 v20, v17
v_add_f32 v20, v20, v17
v_mov_b32 v17, v20
s_nop 1
v_permlane32_swap_b32 v20, v17
v_add_f32 v20, v20, v17
v_mov_b32 v18, v21
s_nop 1
v_permlane16_swap_b32 v21, v18
v_add_f32 v21, v21, v18
v_mov_b32 v18, v21
s_nop 1
v_permlane32_swap_b32 v21, v18
v_add_f32 v21, v21, v18
s_lshr_b32 s58, s42, 4
s_lshl_b32 s57, s63, 7
s_add_u32 s58, s58, s57
s_add_u32 s58, s58, s60
s_add_u32 s54, s58, 14942208
v_lshlrev_b32 v17, 3, v0
s_mov_b64 exec, 0xffff
buffer_store_dwordx2 v[20:21], v17, s[24:27], s54 offen sc1
s_mov_b64 exec, -1
s_add_u32 m0, s51, 114688
s_add_u32 s40, s72, 0
buffer_load_dwordx4 v1, s[24:27], s40 offen offset:0 sc1 lds
buffer_load_dwordx4 v1, s[24:27], s40 offen offset:1024 sc1 lds
buffer_load_dwordx4 v1, s[24:27], s40 offen offset:2048 sc1 lds
buffer_load_dwordx4 v1, s[24:27], s40 offen offset:3072 sc1 lds
s_add_u32 m0, s51, 131072
s_add_u32 s40, s72, 4096
buffer_load_dwordx4 v1, s[24:27], s40 offen offset:0 sc1 lds
buffer_load_dwordx4 v1, s[24:27], s40 offen offset:1024 sc1 lds
buffer_load_dwordx4 v1, s[24:27], s40 offen offset:2048 sc1 lds
buffer_load_dwordx4 v1, s[24:27], s40 offen offset:3072 sc1 lds
s_add_u32 s61, s61, 1
s_or_b32 s57, s44, s61
v_mov_b32 v22, s57
v_mov_b32 v23, s45
s_lshl_b32 s58, s37, 3
s_cmp_lg_u32 s38, 0
s_waitcnt vmcnt(8)
s_barrier
s_cbranch_scc1 Lsig2192
s_mov_b64 exec, 1
buffer_store_dwordx2 v[22:23], v12, s[24:27], s58 offen sc1
s_mov_b64 exec, -1
Lsig2192:
s_add_u32 m0, s51, 147456
s_add_u32 s40, s72, 8192
buffer_load_dwordx4 v1, s[24:27], s40 offen offset:0 sc1 lds
buffer_load_dwordx4 v1, s[24:27], s40 offen offset:1024 sc1 lds
buffer_load_dwordx4 v1, s[24:27], s40 offen offset:2048 sc1 lds
buffer_load_dwordx4 v1, s[24:27], s40 offen offset:3072 sc1 lds
v_lshrrev_b32 v17, 1, v14
v_and_b32 v17, 3, v17
v_lshl_add_u32 v18, v14, 7, v16
v_add_u32 v18, s51, v18
v_xor_b32 v40, 0, v17
v_lshl_add_u32 v40, v40, 5, v18
v_xor_b32 v41, 1, v17
v_lshl_add_u32 v41, v41, 5, v18
v_xor_b32 v42, 2, v17
v_lshl_add_u32 v42, v42, 5, v18
v_xor_b32 v43, 3, v17
v_lshl_add_u32 v43, v43, 5, v18
v_add_u32 v44, 0x10000, v40
v_add_u32 v48, 0x20000, v40
v_add_u32 v45, 0x10000, v41
v_add_u32 v49, 0x20000, v41
v_add_u32 v46, 0x10000, v42
v_add_u32 v50, 0x20000, v42
v_add_u32 v47, 0x10000, v43
v_add_u32 v51, 0x20000, v43
v_mov_b32 v32, v1
v_add_u32 v33, 57344, v32
s_add_u32 s58, s43, s60
s_add_u32 s58, s58, 2097152
v_add_u32 v24, s58, v1
v_add_u32 v25, 0x4000, v24
s_lshr_b32 s58, s43, 4
s_add_u32 s58, s58, s60
s_add_u32 s58, s58, 14942208
v_add_u32 v27, s58, v60
s_cmp_eq_u32 s39, 0
s_cbranch_scc1 Lna3
v_accvgpr_read_b32 v200, a228
v_accvgpr_read_b32 v201, a229
v_accvgpr_read_b32 v202, a230
v_accvgpr_read_b32 v203, a231
v_accvgpr_read_b32 v204, a232
v_accvgpr_read_b32 v205, a233
v_accvgpr_read_b32 v206, a234
v_accvgpr_read_b32 v207, a235
v_accvgpr_read_b32 v208, a236
v_accvgpr_read_b32 v209, a237
v_accvgpr_read_b32 v210, a238
v_accvgpr_read_b32 v211, a239
v_accvgpr_read_b32 v212, a240
v_accvgpr_read_b32 v213, a241
v_accvgpr_read_b32 v214, a242
v_accvgpr_read_b32 v215, a243
v_accvgpr_read_b32 v216, a244
v_accvgpr_read_b32 v217, a245
v_accvgpr_read_b32 v218, a246
v_accvgpr_read_b32 v219, a247
v_accvgpr_read_b32 v220, a248
v_accvgpr_read_b32 v221, a249
v_accvgpr_read_b32 v222, a250
v_accvgpr_read_b32 v223, a251
v_accvgpr_read_b32 v224, a252
v_accvgpr_read_b32 v225, a253
v_accvgpr_read_b32 v226, a254
v_accvgpr_read_b32 v227, a255
Lna3:
s_cmp_lg_u32 s38, 0
s_cbranch_scc1 Lpoll2272x
s_mov_b32 s98, 0x40000
s_or_b32 s57, s44, s61
s_sub_u32 s58, 16, s61
Lpoll2272:
buffer_load_dwordx2 v[248:249], v12, s[24:27], 0 offen sc1
Lpoll2272p:
s_sub_u32 s98, s98, 1
s_cbranch_scc1 Lend
s_waitcnt vmcnt(0)
v_subrev_u32 v248, s57, v248
v_xor_b32 v249, s45, v249
v_cmp_gt_u32 vcc, s58, v248
v_cmp_eq_u32 s[2:3], 0, v249
s_nop 1
s_and_b64 vcc, vcc, s[2:3]
s_cmp_eq_u64 vcc, exec
s_cbranch_scc1 Lpoll2272x
s_sleep 6
s_branch Lpoll2272
Lpoll2272x:
s_waitcnt vmcnt(0) lgkmcnt(0)
s_barrier
buffer_load_dwordx4 a[0:3], v24, s[24:27], s64 offen offset:0 sc1
buffer_load_dwordx4 a[64:67], v25, s[24:27], s64 offen offset:0 sc1
buffer_load_dwordx4 a[4:7], v24, s[24:27], s64 offen offset:1024 sc1
buffer_load_dwordx4 a[68:71], v25, s[24:27], s64 offen offset:1024 sc1
buffer_load_dwordx4 a[8:11], v24, s[24:27], s64 offen offset:2048 sc1
buffer_load_dwordx4 a[72:75], v25, s[24:27], s64 offen offset:2048 sc1
s_cmp_lg_u32 s39, 0
s_cbranch_scc1 Lcp3
s_lshl_b32 s57, s38, 10
v_add_u32 v52, s57, v32
s_min_u32 s57, s57, 2048
s_add_u32 s57, s57, 4096
v_add_u32 v53, s57, v32
v_add_u32 v54, 0x10000, v52
v_add_u32 v55, 0x10000, v53
ds_read_b128 v[136:139], v52 offset:0
ds_read_b128 v[140:143], v53 offset:0
ds_read_b128 v[144:147], v52 offset:7168
ds_read_b128 v[148:151], v53 offset:7168
ds_read_b128 v[152:155], v52 offset:14336
ds_read_b128 v[156:159], v53 offset:14336
s_waitcnt lgkmcnt(4)
v_mfma_f32_16x16x32_bf16 a[228:231], v[136:139], v[28:31], 0
v_mfma_f32_16x16x32_bf16 a[232:235], v[140:143], v[28:31], 0
ds_read_b128 v[160:163], v52 offset:21504
ds_read_b128 v[164:167], v53 offset:21504
s_waitcnt lgkmcnt(4)
v_mfma_f32_16x16x32_bf16 a[228:231], v[144:147], v[28:31], a[228:231]
v_mfma_f32_16x16x32_bf16 a[232:235], v[148:151], v[28:31], a[232:235]
ds_read_b128 v[168:171], v52 offset:28672
ds_read_b128 v[172:175], v53 offset:28672
s_waitcnt lgkmcnt(4)
v_mfma_f32_16x16x32_bf16 a[228:231], v[152:155], v[28:31], a[228:231]
v_mfma_f32_16x16x32_bf16 a[232:235], v[156:159], v[28:31], a[232:235]
ds_read_b128 v[176:179], v52 offset:35840
ds_read_b128 v[180:183], v53 offset:35840
s_waitcnt lgkmcnt(4)
v_mfma_f32_16x16x32_bf16 a[228:231], v[160:163], v[28:31], a[228:231]
v_mfma_f32_16x16x32_bf16 a[232:235], v[164:167], v[28:31], a[232:235]
ds_read_b128 v[136:139], v52 offset:43008
ds_read_b128 v[140:143], v53 offset:43008
s_waitcnt lgkmcnt(4)
v_mfma_f32_16x16x32_bf16 a[228:231], v[168:171], v[28:31], a[228:231]
v_mfma_f32_16x16x32_bf16 a[232:235], v[172:175], v[28:31], a[232:235]
ds_read_b128 v[144:147], v52 offset:50176
ds_read_b128 v[148:151], v53 offset:50176
s_waitcnt lgkmcnt(4)
v_mfma_f32_16x16x32_bf16 a[228:231], v[176:179], v[28:31], a[228:231]
v_mfma_f32_16x16x32_bf16 a[232:235], v[180:183], v[28:31], a[232:235]
ds_read_b128 v[152:155], v52 offset:57344
ds_read_b128 v[156:159], v53 offset:57344
s_waitcnt lgkmcnt(4)
v_mfma_f32_16x16x32_bf16 a[228:231], v[136:139], v[28:31], a[228:231]
v_mfma_f32_16x16x32_bf16 a[232:235], v[140:143], v[28:31], a[232:235]
ds_read_b128 v[160:163], v52 offset:64512
ds_read_b128 v[164:167], v53 offset:64512
s_waitcnt lgkmcnt(4)
v_mfma_f32_16x16x32_bf16 a[228:231], v[144:147], v[28:31], a[228:231]
v_mfma_f32_16x16x32_bf16 a[232:235], v[148:151], v[28:31], a[232:235]
ds_read_b128 v[168:171], v54 offset:6144
ds_read_b128 v[172:175], v55 offset:6144
s_waitcnt lgkmcnt(4)
v_mfma_f32_16x16x32_bf16 a[228:231], v[152:155], v[28:31], a[228:231]
v_mfma_f32_16x16x32_bf16 a[232:235], v[156:159], v[28:31], a[232:235]
ds_read_b128 v[176:179], v54 offset:13312
ds_read_b128 v[180:183], v55 offset:13312
s_waitcnt lgkmcnt(4)
v_mfma_f32_16x16x32_bf16 a[228:231], v[160:163], v[28:31], a[228:231]
v_mfma_f32_16x16x32_bf16 a[232:235], v[164:167], v[28:31], a[232:235]
ds_read_b128 v[136:139], v54 offset:20480
ds_read_b128 v[140:143], v55 offset:20480
s_waitcnt lgkmcnt(4)
v_mfma_f32_16x16x32_bf16 a[228:231], v[168:171], v[28:31], a[228:231]
v_mfma_f32_16x16x32_bf16 a[232:235], v[172:175], v[28:31], a[232:235]
ds_read_b128 v[144:147], v54 offset:27648
ds_read_b128 v[148:151], v55 offset:27648
s_waitcnt lgkmcnt(4)
v_mfma_f32_16x16x32_bf16 a[228:231], v[176:179], v[28:31], a[228:231]
v_mfma_f32_16x16x32_bf16 a[232:235], v[180:183], v[28:31], a[232:235]
ds_read_b128 v[152:155], v54 offset:34816
ds_read_b128 v[156:159], v55 offset:34816
s_waitcnt lgkmcnt(4)
v_mfma_f32_16x16x32_bf16 a[228:231], v[136:139], v[28:31], a[228:231]
v_mfma_f32_16x16x32_bf16 a[232:235], v[140:143], v[28:31], a[232:235]
ds_read_b128 v[160:163], v54 offset:41984
ds_read_b128 v[164:167], v55 offset:41984
s_waitcnt lgkmcnt(4)
v_mfma_f32_16x16x32_bf16 a[228:231], v[144:147], v[28:31], a[228:231]
v_mfma_f32_16x16x32_bf16 a[232:235], v[148:151], v[28:31], a[232:235]
s_waitcnt lgkmcnt(2)
v_mfma_f32_16x16x32_bf16 a[228:231], v[152:155], v[28:31], a[228:231]
v_mfma_f32_16x16x32_bf16 a[232:235], v[156:159], v[28:31], a[232:235]
s_waitcnt lgkmcnt(0)
v_mfma_f32_16x16x32_bf16 a[228:231], v[160:163], v[28:31], a[228:231]
v_mfma_f32_16x16x32_bf16 a[232:235], v[164:167], v[28:31], a[232:235]
Lcp3:
ds_read_b64_tr_b16 a[128:129], v44 offset:49152
ds_read_b64_tr_b16 a[130:131], v44 offset:51200
ds_read_b64_tr_b16 a[132:133], v45 offset:49152
ds_read_b64_tr_b16 a[134:135], v45 offset:51200
ds_read_b64_tr_b16 a[136:137], v46 offset:49152
ds_read_b64_tr_b16 a[138:139], v46 offset:51200
ds_read_b64_tr_b16 a[140:141], v47 offset:49152
ds_read_b64_tr_b16 a[142:143], v47 offset:51200
ds_read_b64_tr_b16 a[144:145], v48 offset:0
ds_read_b64_tr_b16 a[146:147], v48 offset:2048
ds_read_b64_tr_b16 a[148:149], v49 offset:0
ds_read_b64_tr_b16 a[150:151], v49 offset:2048
ds_read_b64_tr_b16 a[152:153], v50 offset:0
ds_read_b64_tr_b16 a[154:155], v50 offset:2048
ds_read_b64_tr_b16 a[156:157], v51 offset:0
ds_read_b64_tr_b16 a[158:159], v51 offset:2048
ds_read_b64_tr_b16 a[160:161], v48 offset:16384
ds_read_b64_tr_b16 a[162:163], v48 offset:18432
ds_read_b64_tr_b16 a[164:165], v49 offset:16384
ds_read_b64_tr_b16 a[166:167], v49 offset:18432
ds_read_b64_tr_b16 a[168:169], v50 offset:16384
ds_read_b64_tr_b16 a[170:171], v50 offset:18432
ds_read_b64_tr_b16 a[172:173], v51 offset:16384
ds_read_b64_tr_b16 a[174:175], v51 offset:18432
ds_read_b128 v[136:139], v32 offset:0
ds_read_b128 v[140:143], v32 offset:1024
ds_read_b128 v[144:147], v32 offset:2048
ds_read_b128 v[148:151], v32 offset:3072
ds_read_b128 v[152:155], v32 offset:4096
ds_read_b128 v[156:159], v32 offset:5120
ds_read_b128 v[160:163], v32 offset:6144
s_waitcnt vmcnt(4) lgkmcnt(0)
v_mfma_f32_16x16x32_bf16 v[64:67], v[136:139], a[0:3], 0
ds_read_b128 v[164:167], v32 offset:7168
buffer_load_dwordx4 a[12:15], v24, s[24:27], s64 offen offset:3072 sc1
v_mfma_f32_16x16x32_bf16 v[92:95], v[136:139], a[64:67], 0
v_mfma_f32_16x16x32_bf16 v[68:71], v[140:143], a[0:3], 0
ds_read_b128 v[168:171], v32 offset:8192
buffer_load_dwordx4 a[76:79], v25, s[24:27], s64 offen offset:3072 sc1
v_mfma_f32_16x16x32_bf16 v[96:99], v[140:143], a[64:67], 0
v_mfma_f32_16x16x32_bf16 v[72:75], v[144:147], a[0:3], 0
ds_read_b128 v[172:175], v32 offset:9216
v_mfma_f32_16x16x32_bf16 v[100:103], v[144:147], a[64:67], 0
v_mfma_f32_16x16x32_bf16 v[76:79], v[148:151], a[0:3], 0
ds_read_b128 v[176:179], v32 offset:10240
buffer_load_dwordx4 a[16:19], v24, s[24:27], s65 offen offset:0 sc1
v_mfma_f32_16x16x32_bf16 v[104:107], v[148:151], a[64:67], 0
v_mfma_f32_16x16x32_bf16 v[80:83], v[152:155], a[0:3], 0
ds_read_b128 v[180:183], v32 offset:11264
v_mfma_f32_16x16x32_bf16 v[108:111], v[152:155], a[64:67], 0
v_mfma_f32_16x16x32_bf16 v[84:87], v[156:159], a[0:3], 0
ds_read_b128 v[184:187], v32 offset:12288
buffer_load_dwordx4 a[80:83], v25, s[24:27], s65 offen offset:0 sc1
v_mfma_f32_16x16x32_bf16 v[112:115], v[156:159], a[64:67], 0
v_mfma_f32_16x16x32_bf16 v[88:91], v[160:163], a[0:3], 0
ds_read_b128 v[188:191], v32 offset:13312
v_mfma_f32_16x16x32_bf16 v[116:119], v[160:163], a[64:67], 0
s_waitcnt vmcnt(6) lgkmcnt(5)
v_mfma_f32_16x16x32_bf16 v[64:67], v[164:167], a[4:7], v[64:67]
ds_read_b128 v[136:139], v32 offset:14336
buffer_load_dwordx4 a[20:23], v24, s[24:27], s65 offen offset:1024 sc1
v_mfma_f32_16x16x32_bf16 v[92:95], v[164:167], a[68:71], v[92:95]
v_mfma_f32_16x16x32_bf16 v[68:71], v[168:171], a[4:7], v[68:71]
ds_read_b128 v[140:143], v32 offset:15360
v_mfma_f32_16x16x32_bf16 v[96:99], v[168:171], a[68:71], v[96:99]
s_waitcnt lgkmcnt(5)
v_mfma_f32_16x16x32_bf16 v[72:75], v[172:175], a[4:7], v[72:75]
ds_read_b128 v[144:147], v32 offset:16384
v_mfma_f32_16x16x32_bf16 v[100:103], v[172:175], a[68:71], v[100:103]
v_mfma_f32_16x16x32_bf16 v[76:79], v[176:179], a[4:7], v[76:79]
ds_read_b128 v[148:151], v32 offset:17408
buffer_load_dwordx4 a[84:87], v25, s[24:27], s65 offen offset:1024 sc1
v_mfma_f32_16x16x32_bf16 v[104:107], v[176:179], a[68:71], v[104:107]
s_waitcnt lgkmcnt(5)
v_mfma_f32_16x16x32_bf16 v[80:83], v[180:183], a[4:7], v[80:83]
ds_read_b128 v[152:155], v32 offset:18432
v_mfma_f32_16x16x32_bf16 v[108:111], v[180:183], a[68:71], v[108:111]
v_mfma_f32_16x16x32_bf16 v[84:87], v[184:187], a[4:7], v[84:87]
ds_read_b128 v[156:159], v32 offset:19456
v_mfma_f32_16x16x32_bf16 v[112:115], v[184:187], a[68:71], v[112:115]
s_waitcnt lgkmcnt(6)
v_mfma_f32_16x16x32_bf16 v[88:91], v[188:191], a[4:7], v[88:91]
ds_read_b128 v[160:163], v32 offset:20480
v_mfma_f32_16x16x32_bf16 v[116:119], v[188:191], a[68:71], v[116:119]
s_waitcnt vmcnt(6) lgkmcnt(5)
v_mfma_f32_16x16x32_bf16 v[64:67], v[136:139], a[8:11], v[64:67]
ds_read_b128 v[164:167], v32 offset:21504
buffer_load_dwordx4 a[24:27], v24, s[24:27], s65 offen offset:2048 sc1
v_mfma_f32_16x16x32_bf16 v[92:95], v[136:139], a[72:75], v[92:95]
v_mfma_f32_16x16x32_bf16 v[68:71], v[140:143], a[8:11], v[68:71]
ds_read_b128 v[168:171], v32 offset:22528
buffer_load_dwordx4 a[88:91], v25, s[24:27], s65 offen offset:2048 sc1
v_mfma_f32_16x16x32_bf16 v[96:99], v[140:143], a[72:75], v[96:99]
s_waitcnt lgkmcnt(5)
v_mfma_f32_16x16x32_bf16 v[72:75], v[144:147], a[8:11], v[72:75]
ds_read_b128 v[172:175], v32 offset:23552
buffer_load_dwordx2 v[228:229], v27, s[24:27], 0 offen offset:0 sc1
v_mfma_f32_16x16x32_bf16 v[100:103], v[144:147], a[72:75], v[100:103]
v_mfma_f32_16x16x32_bf16 v[76:79], v[148:151], a[8:11], v[76:79]
ds_read_b128 v[176:179], v32 offset:24576
buffer_load_dwordx2 v[230:231], v27, s[24:27], 0 offen offset:128 sc1
v_mfma_f32_16x16x32_bf16 v[104:107], v[148:151], a[72:75], v[104:107]
s_waitcnt lgkmcnt(5)
v_mfma_f32_16x16x32_bf16 v[80:83], v[152:155], a[8:11], v[80:83]
ds_read_b128 v[180:183], v32 offset:25600
buffer_load_dwordx2 v[232:233], v27, s[24:27], 0 offen offset:1024 sc1
v_mfma_f32_16x16x32_bf16 v[108:111], v[152:155], a[72:75], v[108:111]
v_mfma_f32_16x16x32_bf16 v[84:87], v[156:159], a[8:11], v[84:87]
ds_read_b128 v[184:187], v32 offset:26624
buffer_load_dwordx2 v[234:235], v27, s[24:27], 0 offen offset:1152 sc1
v_mfma_f32_16x16x32_bf16 v[112:115], v[156:159], a[72:75], v[112:115]
s_waitcnt lgkmcnt(6)
v_mfma_f32_16x16x32_bf16 v[88:91], v[160:163], a[8:11], v[88:91]
ds_read_b128 v[188:191], v32 offset:27648
v_mfma_f32_16x16x32_bf16 v[116:119], v[160:163], a[72:75], v[116:119]
s_waitcnt vmcnt(10) lgkmcnt(5)
v_mfma_f32_16x16x32_bf16 v[64:67], v[164:167], a[12:15], v[64:67]
ds_read_b128 v[136:139], v32 offset:28672
buffer_load_dwordx4 a[28:31], v24, s[24:27], s65 offen offset:3072 sc1
v_mfma_f32_16x16x32_bf16 v[92:95], v[164:167], a[76:79], v[92:95]
v_mfma_f32_16x16x32_bf16 v[68:71], v[168:171], a[12:15], v[68:71]
ds_read_b128 v[140:143], v32 offset:29696
v_mfma_f32_16x16x32_bf16 v[96:99], v[168:171], a[76:79], v[96:99]
s_waitcnt lgkmcnt(5)
v_mfma_f32_16x16x32_bf16 v[72:75], v[172:175], a[12:15], v[72:75]
ds_read_b128 v[144:147], v32 offset:30720
v_mfma_f32_16x16x32_bf16 v[100:103], v[172:175], a[76:79], v[100:103]
v_mfma_f32_16x16x32_bf16 v[76:79], v[176:179], a[12:15], v[76:79]
ds_read_b128 v[148:151], v32 offset:31744
buffer_load_dwordx4 a[92:95], v25, s[24:27], s65 offen offset:3072 sc1
v_mfma_f32_16x16x32_bf16 v[104:107], v[176:179], a[76:79], v[104:107]
s_waitcnt lgkmcnt(5)
v_mfma_f32_16x16x32_bf16 v[80:83], v[180:183], a[12:15], v[80:83]
ds_read_b128 v[152:155], v32 offset:32768
v_mfma_f32_16x16x32_bf16 v[108:111], v[180:183], a[76:79], v[108:111]
v_mfma_f32_16x16x32_bf16 v[84:87], v[184:187], a[12:15], v[84:87]
ds_read_b128 v[156:159], v32 offset:33792
v_mfma_f32_16x16x32_bf16 v[112:115], v[184:187], a[76:79], v[112:115]
s_waitcnt lgkmcnt(6)
v_mfma_f32_16x16x32_bf16 v[88:91], v[188:191], a[12:15], v[88:91]
ds_read_b128 v[160:163], v32 offset:34816
v_mfma_f32_16x16x32_bf16 v[116:119], v[188:191], a[76:79], v[116:119]
s_waitcnt vmcnt(10) lgkmcnt(5)
v_mfma_f32_16x16x32_bf16 v[64:67], v[136:139], a[16:19], v[64:67]
ds_read_b128 v[164:167], v32 offset:35840
buffer_load_dwordx4 a[32:35], v24, s[24:27], s66 offen offset:0 sc1
v_mfma_f32_16x16x32_bf16 v[92:95], v[136:139], a[80:83], v[92:95]
v_mfma_f32_16x16x32_bf16 v[68:71], v[140:143], a[16:19], v[68:71]
ds_read_b128 v[168:171], v32 offset:36864
v_mfma_f32_16x16x32_bf16 v[96:99], v[140:143], a[80:83], v[96:99]
s_waitcnt lgkmcnt(5)
v_mfma_f32_16x16x32_bf16 v[72:75], v[144:147], a[16:19], v[72:75]
ds_read_b128 v[172:175], v32 offset:37888
v_mfma_f32_16x16x32_bf16 v[100:103], v[144:147], a[80:83], v[100:103]
v_mfma_f32_16x16x32_bf16 v[76:79], v[148:151], a[16:19], v[76:79]
ds_read_b128 v[176:179], v32 offset:38912
buffer_load_dwordx4 a[96:99], v25, s[24:27], s66 offen offset:0 sc1
v_mfma_f32_16x16x32_bf16 v[104:107], v[148:151], a[80:83], v[104:107]
s_waitcnt lgkmcnt(5)
v_mfma_f32_16x16x32_bf16 v[80:83], v[152:155], a[16:19], v[80:83]
ds_read_b128 v[180:183], v32 offset:39936
v_mfma_f32_16x16x32_bf16 v[108:111], v[152:155], a[80:83], v[108:111]
v_mfma_f32_16x16x32_bf16 v[84:87], v[156:159], a[16:19], v[84:87]
ds_read_b128 v[184:187], v32 offset:40960
v_mfma_f32_16x16x32_bf16 v[112:115], v[156:159], a[80:83], v[112:115]
s_waitcnt lgkmcnt(6)
v_mfma_f32_16x16x32_bf16 v[88:91], v[160:163], a[16:19], v[88:91]
ds_read_b128 v[188:191], v32 offset:41984
v_mfma_f32_16x16x32_bf16 v[116:119], v[160:163], a[80:83], v[116:119]
s_waitcnt vmcnt(10) lgkmcnt(5)
v_mfma_f32_16x16x32_bf16 v[64:67], v[164:167], a[20:23], v[64:67]
ds_read_b128 v[136:139], v32 offset:43008
buffer_load_dwordx4 a[36:39], v24, s[24:27], s66 offen offset:1024 sc1
v_mfma_f32_16x16x32_bf16 v[92:95], v[164:167], a[84:87], v[92:95]
v_mfma_f32_16x16x32_bf16 v[68:71], v[168:171], a[20:23], v[68:71]
ds_read_b128 v[140:143], v32 offset:44032
v_mfma_f32_16x16x32_bf16 v[96:99], v[168:171], a[84:87], v[96:99]
s_waitcnt lgkmcnt(5)
v_mfma_f32_16x16x32_bf16 v[72:75], v[172:175], a[20:23], v[72:75]
ds_read_b128 v[144:147], v32 offset:45056
v_mfma_f32_16x16x32_bf16 v[100:103], v[172:175], a[84:87], v[100:103]
v_mfma_f32_16x16x32_bf16 v[76:79], v[176:179], a[20:23], v[76:79]
ds_read_b128 v[148:151], v32 offset:46080
buffer_load_dwordx4 a[100:103], v25, s[24:27], s66 offen offset:1024 sc1
v_mfma_f32_16x16x32_bf16 v[104:107], v[176:179], a[84:87], v[104:107]
s_waitcnt lgkmcnt(5)
v_mfma_f32_16x16x32_bf16 v[80:83], v[180:183], a[20:23], v[80:83]
ds_read_b128 v[152:155], v32 offset:47104
v_mfma_f32_16x16x32_bf16 v[108:111], v[180:183], a[84:87], v[108:111]
v_mfma_f32_16x16x32_bf16 v[84:87], v[184:187], a[20:23], v[84:87]
ds_read_b128 v[156:159], v32 offset:48128
v_mfma_f32_16x16x32_bf16 v[112:115], v[184:187], a[84:87], v[112:115]
s_waitcnt lgkmcnt(6)
v_mfma_f32_16x16x32_bf16 v[88:91], v[188:191], a[20:23], v[88:91]
ds_read_b128 v[160:163], v32 offset:49152
v_mfma_f32_16x16x32_bf16 v[116:119], v[188:191], a[84:87], v[116:119]
s_waitcnt vmcnt(10) lgkmcnt(5)
v_mfma_f32_16x16x32_bf16 v[64:67], v[136:139], a[24:27], v[64:67]
ds_read_b128 v[164:167], v32 offset:50176
buffer_load_dwordx4 a[40:43], v24, s[24:27], s66 offen offset:2048 sc1
v_mfma_f32_16x16x32_bf16 v[92:95], v[136:139], a[88:91], v[92:95]
v_mfma_f32_16x16x32_bf16 v[68:71], v[140:143], a[24:27], v[68:71]
ds_read_b128 v[168:171], v32 offset:51200
v_mfma_f32_16x16x32_bf16 v[96:99], v[140:143], a[88:91], v[96:99]
s_waitcnt lgkmcnt(5)
v_mfma_f32_16x16x32_bf16 v[72:75], v[144:147], a[24:27], v[72:75]
ds_read_b128 v[172:175], v32 offset:52224
v_mfma_f32_16x16x32_bf16 v[100:103], v[144:147], a[88:91], v[100:103]
v_mfma_f32_16x16x32_bf16 v[76:79], v[148:151], a[24:27], v[76:79]
ds_read_b128 v[176:179], v32 offset:53248
buffer_load_dwordx4 a[104:107], v25, s[24:27], s66 offen offset:2048 sc1
v_mfma_f32_16x16x32_bf16 v[104:107], v[148:151], a[88:91], v[104:107]
s_waitcnt lgkmcnt(5)
v_mfma_f32_16x16x32_bf16 v[80:83], v[152:155], a[24:27], v[80:83]
ds_read_b128 v[180:183], v32 offset:54272
v_mfma_f32_16x16x32_bf16 v[108:111], v[152:155], a[88:91], v[108:111]
v_mfma_f32_16x16x32_bf16 v[84:87], v[156:159], a[24:27], v[84:87]
ds_read_b128 v[184:187], v32 offset:55296
v_mfma_f32_16x16x32_bf16 v[112:115], v[156:159], a[88:91], v[112:115]
s_waitcnt lgkmcnt(6)
v_mfma_f32_16x16x32_bf16 v[88:91], v[160:163], a[24:27], v[88:91]
ds_read_b128 v[188:191], v32 offset:56320
v_mfma_f32_16x16x32_bf16 v[116:119], v[160:163], a[88:91], v[116:119]
s_waitcnt vmcnt(6) lgkmcnt(5)
v_mfma_f32_16x16x32_bf16 v[64:67], v[164:167], a[28:31], v[64:67]
ds_read_b128 v[136:139], v33 offset:0
buffer_load_dwordx4 a[44:47], v24, s[24:27], s66 offen offset:3072 sc1
v_mfma_f32_16x16x32_bf16 v[92:95], v[164:167], a[92:95], v[92:95]
v_mfma_f32_16x16x32_bf16 v[68:71], v[168:171], a[28:31], v[68:71]
ds_read_b128 v[140:143], v33 offset:1024
v_mfma_f32_16x16x32_bf16 v[96:99], v[168:171], a[92:95], v[96:99]
s_waitcnt lgkmcnt(5)
v_mfma_f32_16x16x32_bf16 v[72:75], v[172:175], a[28:31], v[72:75]
ds_read_b128 v[144:147], v33 offset:2048
v_mfma_f32_16x16x32_bf16 v[100:103], v[172:175], a[92:95], v[100:103]
v_mfma_f32_16x16x32_bf16 v[76:79], v[176:179], a[28:31], v[76:79]
ds_read_b128 v[148:151], v33 offset:3072
buffer_load_dwordx4 a[108:111], v25, s[24:27], s66 offen offset:3072 sc1
v_mfma_f32_16x16x32_bf16 v[104:107], v[176:179], a[92:95], v[104:107]
s_waitcnt lgkmcnt(5)
v_mfma_f32_16x16x32_bf16 v[80:83], v[180:183], a[28:31], v[80:83]
ds_read_b128 v[152:155], v33 offset:4096
v_mfma_f32_16x16x32_bf16 v[108:111], v[180:183], a[92:95], v[108:111]
v_mfma_f32_16x16x32_bf16 v[84:87], v[184:187], a[28:31], v[84:87]
ds_read_b128 v[156:159], v33 offset:5120
v_mfma_f32_16x16x32_bf16 v[112:115], v[184:187], a[92:95], v[112:115]
s_waitcnt lgkmcnt(6)
v_mfma_f32_16x16x32_bf16 v[88:91], v[188:191], a[28:31], v[88:91]
ds_read_b128 v[160:163], v33 offset:6144
v_mfma_f32_16x16x32_bf16 v[116:119], v[188:191], a[92:95], v[116:119]
s_waitcnt vmcnt(6) lgkmcnt(5)
v_mfma_f32_16x16x32_bf16 v[64:67], v[136:139], a[32:35], v[64:67]
ds_read_b128 v[164:167], v33 offset:7168
buffer_load_dwordx4 a[48:51], v24, s[24:27], s67 offen offset:0 sc1
v_mfma_f32_16x16x32_bf16 v[92:95], v[136:139], a[96:99], v[92:95]
v_mfma_f32_16x16x32_bf16 v[68:71], v[140:143], a[32:35], v[68:71]
ds_read_b128 v[168:171], v33 offset:8192
v_mfma_f32_16x16x32_bf16 v[96:99], v[140:143], a[96:99], v[96:99]
s_waitcnt lgkmcnt(5)
v_mfma_f32_16x16x32_bf16 v[72:75], v[144:147], a[32:35], v[72:75]
ds_read_b128 v[172:175], v33 offset:9216
v_mfma_f32_16x16x32_bf16 v[100:103], v[144:147], a[96:99], v[100:103]
v_mfma_f32_16x16x32_bf16 v[76:79], v[148:151], a[32:35], v[76:79]
ds_read_b128 v[176:179], v33 offset:10240
buffer_load_dwordx4 a[112:115], v25, s[24:27], s67 offen offset:0 sc1
v_mfma_f32_16x16x32_bf16 v[104:107], v[148:151], a[96:99], v[104:107]
s_waitcnt lgkmcnt(5)
v_mfma_f32_16x16x32_bf16 v[80:83], v[152:155], a[32:35], v[80:83]
ds_read_b128 v[180:183], v33 offset:11264
v_mfma_f32_16x16x32_bf16 v[108:111], v[152:155], a[96:99], v[108:111]
v_mfma_f32_16x16x32_bf16 v[84:87], v[156:159], a[32:35], v[84:87]
ds_read_b128 v[184:187], v33 offset:12288
v_mfma_f32_16x16x32_bf16 v[112:115], v[156:159], a[96:99], v[112:115]
s_waitcnt lgkmcnt(6)
v_mfma_f32_16x16x32_bf16 v[88:91], v[160:163], a[32:35], v[88:91]
ds_read_b128 v[188:191], v33 offset:13312
v_mfma_f32_16x16x32_bf16 v[116:119], v[160:163], a[96:99], v[116:119]
s_waitcnt vmcnt(6) lgkmcnt(5)
v_mfma_f32_16x16x32_bf16 v[64:67], v[164:167], a[36:39], v[64:67]
ds_read_b128 v[136:139], v33 offset:14336
v_add_f32 v228, v228, v230
v_mfma_f32_16x16x32_bf16 v[92:95], v[164:167], a[100:103], v[92:95]
buffer_load_dwordx4 a[52:55], v24, s[24:27], s67 offen offset:1024 sc1
v_mfma_f32_16x16x32_bf16 v[68:71], v[168:171], a[36:39], v[68:71]
ds_read_b128 v[140:143], v33 offset:15360
v_add_f32 v232, v232, v234
v_mfma_f32_16x16x32_bf16 v[96:99], v[168:171], a[100:103], v[96:99]
s_waitcnt lgkmcnt(5)
v_mfma_f32_16x16x32_bf16 v[72:75], v[172:175], a[36:39], v[72:75]
ds_read_b128 v[144:147], v33 offset:16384
v_add_f32 v229, v229, v231
v_mfma_f32_16x16x32_bf16 v[100:103], v[172:175], a[100:103], v[100:103]
v_mfma_f32_16x16x32_bf16 v[76:79], v[176:179], a[36:39], v[76:79]
ds_read_b128 v[148:151], v33 offset:17408
v_add_f32 v233, v233, v235
v_mfma_f32_16x16x32_bf16 v[104:107], v[176:179], a[100:103], v[104:107]
buffer_load_dwordx4 a[116:119], v25, s[24:27], s67 offen offset:1024 sc1
s_waitcnt lgkmcnt(5)
v_mfma_f32_16x16x32_bf16 v[80:83], v[180:183], a[36:39], v[80:83]
ds_read_b128 v[152:155], v33 offset:18432
v_mov_b32 v17, v228
v_mfma_f32_16x16x32_bf16 v[108:111], v[180:183], a[100:103], v[108:111]
v_mfma_f32_16x16x32_bf16 v[84:87], v[184:187], a[36:39], v[84:87]
ds_read_b128 v[156:159], v33 offset:19456
v_mov_b32 v18, v232
v_mfma_f32_16x16x32_bf16 v[112:115], v[184:187], a[100:103], v[112:115]
s_waitcnt lgkmcnt(6)
v_mfma_f32_16x16x32_bf16 v[88:91], v[188:191], a[36:39], v[88:91]
ds_read_b128 v[160:163], v33 offset:20480
v_permlane16_swap_b32 v228, v17
v_mfma_f32_16x16x32_bf16 v[116:119], v[188:191], a[100:103], v[116:119]
s_waitcnt vmcnt(6) lgkmcnt(5)
v_mfma_f32_16x16x32_bf16 v[64:67], v[136:139], a[40:43], v[64:67]
ds_read_b128 v[164:167], v33 offset:21504
v_permlane16_swap_b32 v232, v18
v_mfma_f32_16x16x32_bf16 v[92:95], v[136:139], a[104:107], v[92:95]
buffer_load_dwordx4 a[56:59], v24, s[24:27], s67 offen offset:2048 sc1
v_mfma_f32_16x16x32_bf16 v[68:71], v[140:143], a[40:43], v[68:71]
ds_read_b128 v[168:171], v33 offset:22528
v_add_f32 v228, v228, v17
v_mfma_f32_16x16x32_bf16 v[96:99], v[140:143], a[104:107], v[96:99]
s_waitcnt lgkmcnt(5)
v_mfma_f32_16x16x32_bf16 v[72:75], v[144:147], a[40:43], v[72:75]
ds_read_b128 v[172:175], v33 offset:23552
v_add_f32 v232, v232, v18
v_mfma_f32_16x16x32_bf16 v[100:103], v[144:147], a[104:107], v[100:103]
v_mfma_f32_16x16x32_bf16 v[76:79], v[148:151], a[40:43], v[76:79]
ds_read_b128 v[176:179], v33 offset:24576
v_mov_b32 v17, v228
v_mfma_f32_16x16x32_bf16 v[104:107], v[148:151], a[104:107], v[104:107]
buffer_load_dwordx4 a[120:123], v25, s[24:27], s67 offen offset:2048 sc1
s_waitcnt lgkmcnt(5)
v_mfma_f32_16x16x32_bf16 v[80:83], v[152:155], a[40:43], v[80:83]
ds_read_b128 v[180:183], v33 offset:25600
v_mov_b32 v18, v232
v_mfma_f32_16x16x32_bf16 v[108:111], v[152:155], a[104:107], v[108:111]
v_mfma_f32_16x16x32_bf16 v[84:87], v[156:159], a[40:43], v[84:87]
ds_read_b128 v[184:187], v33 offset:26624
v_permlane32_swap_b32 v228, v17
v_mfma_f32_16x16x32_bf16 v[112:115], v[156:159], a[104:107], v[112:115]
s_waitcnt lgkmcnt(6)
v_mfma_f32_16x16x32_bf16 v[88:91], v[160:163], a[40:43], v[88:91]
ds_read_b128 v[188:191], v33 offset:27648
v_permlane32_swap_b32 v232, v18
v_mfma_f32_16x16x32_bf16 v[116:119], v[160:163], a[104:107], v[116:119]
s_waitcnt vmcnt(6) lgkmcnt(5)
v_mfma_f32_16x16x32_bf16 v[64:67], v[164:167], a[44:47], v[64:67]
ds_read_b128 v[136:139], v33 offset:28672
v_add_f32 v228, v228, v17
v_mfma_f32_16x16x32_bf16 v[92:95], v[164:167], a[108:111], v[92:95]
buffer_load_dwordx4 a[60:63], v24, s[24:27], s67 offen offset:3072 sc1
v_mfma_f32_16x16x32_bf16 v[68:71], v[168:171], a[44:47], v[68:71]
ds_read_b128 v[140:143], v33 offset:29696
v_add_f32 v232, v232, v18
v_mfma_f32_16x16x32_bf16 v[96:99], v[168:171], a[108:111], v[96:99]
buffer_load_dwordx4 a[124:127], v25, s[24:27], s67 offen offset:3072 sc1
s_waitcnt lgkmcnt(5)
v_mfma_f32_16x16x32_bf16 v[72:75], v[172:175], a[44:47], v[72:75]
ds_read_b128 v[144:147], v33 offset:30720
v_mov_b32 v17, v229
v_mfma_f32_16x16x32_bf16 v[100:103], v[172:175], a[108:111], v[100:103]
s_add_u32 m0, s51, 114688
s_add_u32 s40, s73, 0
buffer_load_dwordx4 v1, s[24:27], s40 offen offset:0 sc1 lds
v_mfma_f32_16x16x32_bf16 v[76:79], v[176:179], a[44:47], v[76:79]
ds_read_b128 v[148:151], v33 offset:31744
v_mov_b32 v18, v233
v_mfma_f32_16x16x32_bf16 v[104:107], v[176:179], a[108:111], v[104:107]
buffer_load_dwordx4 v1, s[24:27], s40 offen offset:1024 sc1 lds
s_waitcnt lgkmcnt(5)
v_mfma_f32_16x16x32_bf16 v[80:83], v[180:183], a[44:47], v[80:83]
ds_read_b128 v[152:155], v33 offset:32768
v_permlane16_swap_b32 v229, v17
v_mfma_f32_16x16x32_bf16 v[108:111], v[180:183], a[108:111], v[108:111]
buffer_load_dwordx4 v1, s[24:27], s40 offen offset:2048 sc1 lds
v_mfma_f32_16x16x32_bf16 v[84:87], v[184:187], a[44:47], v[84:87]
ds_read_b128 v[156:159], v33 offset:33792
v_permlane16_swap_b32 v233, v18
v_mfma_f32_16x16x32_bf16 v[112:115], v[184:187], a[108:111], v[112:115]
buffer_load_dwordx4 v1, s[24:27], s40 offen offset:3072 sc1 lds
s_waitcnt lgkmcnt(6)
v_mfma_f32_16x16x32_bf16 v[88:91], v[188:191], a[44:47], v[88:91]
ds_read_b128 v[160:163], v33 offset:34816
v_add_f32 v229, v229, v17
v_mfma_f32_16x16x32_bf16 v[116:119], v[188:191], a[108:111], v[116:119]
s_waitcnt vmcnt(10) lgkmcnt(5)
v_mfma_f32_16x16x32_bf16 v[64:67], v[136:139], a[48:51], v[64:67]
ds_read_b128 v[164:167], v33 offset:35840
v_add_f32 v233, v233, v18
v_mfma_f32_16x16x32_bf16 v[92:95], v[136:139], a[112:115], v[92:95]
s_add_u32 m0, s51, 131072
s_add_u32 s40, s75, 8192
buffer_load_dwordx4 v1, s[24:27], s40 offen offset:0 sc1 lds
v_mfma_f32_16x16x32_bf16 v[68:71], v[140:143], a[48:51], v[68:71]
ds_read_b128 v[168:171], v33 offset:36864
v_mov_b32 v17, v229
v_mfma_f32_16x16x32_bf16 v[96:99], v[140:143], a[112:115], v[96:99]
buffer_load_dwordx4 v1, s[24:27], s40 offen offset:1024 sc1 lds
s_waitcnt lgkmcnt(5)
v_mfma_f32_16x16x32_bf16 v[72:75], v[144:147], a[48:51], v[72:75]
ds_read_b128 v[172:175], v33 offset:37888
v_mov_b32 v18, v233
v_mfma_f32_16x16x32_bf16 v[100:103], v[144:147], a[112:115], v[100:103]
v_mfma_f32_16x16x32_bf16 v[76:79], v[148:151], a[48:51], v[76:79]
ds_read_b128 v[176:179], v33 offset:38912
v_permlane32_swap_b32 v229, v17
v_mfma_f32_16x16x32_bf16 v[104:107], v[148:151], a[112:115], v[104:107]
buffer_load_dwordx4 v1, s[24:27], s40 offen offset:2048 sc1 lds
s_waitcnt lgkmcnt(5)
v_mfma_f32_16x16x32_bf16 v[80:83], v[152:155], a[48:51], v[80:83]
ds_read_b128 v[180:183], v33 offset:39936
v_permlane32_swap_b32 v233, v18
v_mfma_f32_16x16x32_bf16 v[108:111], v[152:155], a[112:115], v[108:111]
v_mfma_f32_16x16x32_bf16 v[84:87], v[156:159], a[48:51], v[84:87]
ds_read_b128 v[184:187], v33 offset:40960
v_add_f32 v229, v229, v17
v_mfma_f32_16x16x32_bf16 v[112:115], v[156:159], a[112:115], v[112:115]
buffer_load_dwordx4 v1, s[24:27], s40 offen offset:3072 sc1 lds
s_waitcnt lgkmcnt(6)
v_mfma_f32_16x16x32_bf16 v[88:91], v[160:163], a[48:51], v[88:91]
ds_read_b128 v[188:191], v33 offset:41984
v_add_f32 v233, v233, v18
v_mfma_f32_16x16x32_bf16 v[116:119], v[160:163], a[112:115], v[116:119]
s_waitcnt vmcnt(12) lgkmcnt(5)
v_mfma_f32_16x16x32_bf16 v[64:67], v[164:167], a[52:55], v[64:67]
ds_read_b128 v[136:139], v33 offset:43008
v_mul_f32 v228, 0x3b000000, v228
v_mfma_f32_16x16x32_bf16 v[92:95], v[164:167], a[116:119], v[92:95]
s_add_u32 m0, s51, 147456
s_add_u32 s40, s50, 49152
buffer_load_dwordx4 v1, s[24:27], s40 offen offset:0 sc1 lds
v_mfma_f32_16x16x32_bf16 v[68:71], v[168:171], a[52:55], v[68:71]
ds_read_b128 v[140:143], v33 offset:44032
v_mul_f32 v232, 0x3b000000, v232
v_mfma_f32_16x16x32_bf16 v[96:99], v[168:171], a[116:119], v[96:99]
buffer_load_dwordx4 v1, s[24:27], s40 offen offset:1024 sc1 lds
s_waitcnt lgkmcnt(5)
v_mfma_f32_16x16x32_bf16 v[72:75], v[172:175], a[52:55], v[72:75]
ds_read_b128 v[144:147], v33 offset:45056
v_mul_f32 v229, 0x3b000000, v229
v_mfma_f32_16x16x32_bf16 v[100:103], v[172:175], a[116:119], v[100:103]
v_mfma_f32_16x16x32_bf16 v[76:79], v[176:179], a[52:55], v[76:79]
ds_read_b128 v[148:151], v33 offset:46080
v_mul_f32 v233, 0x3b000000, v233
v_mfma_f32_16x16x32_bf16 v[104:107], v[176:179], a[116:119], v[104:107]
buffer_load_dwordx4 v1, s[24:27], s40 offen offset:2048 sc1 lds
s_waitcnt lgkmcnt(5)
v_mfma_f32_16x16x32_bf16 v[80:83], v[180:183], a[52:55], v[80:83]
ds_read_b128 v[152:155], v33 offset:47104
v_fma_f32 v229, -v228, v228, v229
v_mfma_f32_16x16x32_bf16 v[108:111], v[180:183], a[116:119], v[108:111]
v_mfma_f32_16x16x32_bf16 v[84:87], v[184:187], a[52:55], v[84:87]
ds_read_b128 v[156:159], v33 offset:48128
v_fma_f32 v233, -v232, v232, v233
v_mfma_f32_16x16x32_bf16 v[112:115], v[184:187], a[116:119], v[112:115]
buffer_load_dwordx4 v1, s[24:27], s40 offen offset:3072 sc1 lds
s_waitcnt lgkmcnt(6)
v_mfma_f32_16x16x32_bf16 v[88:91], v[188:191], a[52:55], v[88:91]
ds_read_b128 v[160:163], v33 offset:49152
v_max_f32 v229, 0, v229
v_mfma_f32_16x16x32_bf16 v[116:119], v[188:191], a[116:119], v[116:119]
s_waitcnt vmcnt(14) lgkmcnt(5)
v_mfma_f32_16x16x32_bf16 v[64:67], v[136:139], a[56:59], v[64:67]
ds_read_b128 v[164:167], v33 offset:50176
v_max_f32 v233, 0, v233
v_mfma_f32_16x16x32_bf16 v[92:95], v[136:139], a[120:123], v[92:95]
v_mfma_f32_16x16x32_bf16 v[68:71], v[140:143], a[56:59], v[68:71]
ds_read_b128 v[168:171], v33 offset:51200
v_add_f32 v229, 0x3727c5ac, v229
v_mfma_f32_16x16x32_bf16 v[96:99], v[140:143], a[120:123], v[96:99]
s_waitcnt lgkmcnt(5)
v_mfma_f32_16x16x32_bf16 v[72:75], v[144:147], a[56:59], v[72:75]
ds_read_b128 v[172:175], v33 offset:52224
v_add_f32 v233, 0x3727c5ac, v233
v_mfma_f32_16x16x32_bf16 v[100:103], v[144:147], a[120:123], v[100:103]
v_mfma_f32_16x16x32_bf16 v[76:79], v[148:151], a[56:59], v[76:79]
ds_read_b128 v[176:179], v33 offset:53248
v_rsq_f32 v229, v229
v_mfma_f32_16x16x32_bf16 v[104:107], v[148:151], a[120:123], v[104:107]
s_waitcnt lgkmcnt(5)
v_mfma_f32_16x16x32_bf16 v[80:83], v[152:155], a[56:59], v[80:83]
ds_read_b128 v[180:183], v33 offset:54272
v_rsq_f32 v233, v233
v_mfma_f32_16x16x32_bf16 v[108:111], v[152:155], a[120:123], v[108:111]
v_mfma_f32_16x16x32_bf16 v[84:87], v[156:159], a[56:59], v[84:87]
ds_read_b128 v[184:187], v33 offset:55296
v_mul_f32 v230, 0xbfb8aa3b, v229
v_mfma_f32_16x16x32_bf16 v[112:115], v[156:159], a[120:123], v[112:115]
s_waitcnt lgkmcnt(6)
v_mfma_f32_16x16x32_bf16 v[88:91], v[160:163], a[56:59], v[88:91]
ds_read_b128 v[188:191], v33 offset:56320
v_mul_f32 v234, 0xbfb8aa3b, v233
v_mfma_f32_16x16x32_bf16 v[116:119], v[160:163], a[120:123], v[116:119]
s_waitcnt vmcnt(12) lgkmcnt(5)
v_mfma_f32_16x16x32_bf16 v[64:67], v[164:167], a[60:63], v[64:67]
v_mul_f32 v228, v228, v230
v_mfma_f32_16x16x32_bf16 v[92:95], v[164:167], a[124:127], v[92:95]
v_mfma_f32_16x16x32_bf16 v[68:71], v[168:171], a[60:63], v[68:71]
v_mfma_f32_16x16x32_bf16 v[96:99], v[168:171], a[124:127], v[96:99]
s_waitcnt lgkmcnt(3)
v_mfma_f32_16x16x32_bf16 v[72:75], v[172:175], a[60:63], v[72:75]
v_mfma_f32_16x16x32_bf16 v[100:103], v[172:175], a[124:127], v[100:103]
v_mfma_f32_16x16x32_bf16 v[76:79], v[176:179], a[60:63], v[76:79]
v_mul_f32 v232, v232, v234
v_mfma_f32_16x16x32_bf16 v[104:107], v[176:179], a[124:127], v[104:107]
s_waitcnt lgkmcnt(1)
v_mfma_f32_16x16x32_bf16 v[80:83], v[180:183], a[60:63], v[80:83]
v_mfma_f32_16x16x32_bf16 v[108:111], v[180:183], a[124:127], v[108:111]
v_mfma_f32_16x16x32_bf16 v[84:87], v[184:187], a[60:63], v[84:87]
v_mfma_f32_16x16x32_bf16 v[112:115], v[184:187], a[124:127], v[112:115]
s_waitcnt lgkmcnt(0)
v_mfma_f32_16x16x32_bf16 v[88:91], v[188:191], a[60:63], v[88:91]
v_mfma_f32_16x16x32_bf16 v[116:119], v[188:191], a[124:127], v[116:119]
s_waitcnt vmcnt(8)
ds_read_b64_tr_b16 a[176:177], v44 offset:49152
ds_read_b64_tr_b16 a[178:179], v44 offset:51200
ds_read_b64_tr_b16 a[180:181], v45 offset:49152
ds_read_b64_tr_b16 a[182:183], v45 offset:51200
ds_read_b64_tr_b16 a[184:185], v46 offset:49152
ds_read_b64_tr_b16 a[186:187], v46 offset:51200
ds_read_b64_tr_b16 a[188:189], v47 offset:49152
ds_read_b64_tr_b16 a[190:191], v47 offset:51200
s_barrier
s_cmp_lg_u32 s39, 0
s_cbranch_scc1 Lcf3
v_lshlrev_b32 v17, 4, v15
s_lshl_b32 s57, s38, 6
v_add_u32 v19, s57, v17
s_mov_b32 exec_lo, 0x10001
s_mov_b32 exec_hi, 0x10001
ds_write_b128 v19, a[228:231]
ds_write_b128 v19, a[232:235] offset:256
s_mov_b64 exec, -1
s_waitcnt lgkmcnt(0)
s_barrier
ds_read_b128 v[200:203], v17 offset:0
ds_read_b128 v[204:207], v17 offset:64
ds_read_b128 v[208:211], v17 offset:128
ds_read_b128 v[212:215], v17 offset:192
ds_read_b128 v[216:219], v17 offset:256
ds_read_b128 v[220:223], v17 offset:320
ds_read_b128 v[224:227], v17 offset:384
ds_read_b128 a[228:231], v17 offset:0
ds_read_b128 a[232:235], v17 offset:64
ds_read_b128 a[236:239], v17 offset:128
ds_read_b128 a[240:243], v17 offset:192
ds_read_b128 a[244:247], v17 offset:256
ds_read_b128 a[248:251], v17 offset:320
ds_read_b128 a[252:255], v17 offset:384
s_waitcnt lgkmcnt(0)
s_barrier
Lcf3:
s_lshr_b32 s57, s43, 14
s_add_u32 m0, s51, 0
s_add_u32 s40, s73, 4096
buffer_load_dwordx4 v1, s[24:27], s40 offen offset:0 sc1 lds
s_mul_i32 s57, s57, 57344
s_mul_i32 s58, s37, 3584
s_add_u32 s57, s57, s58
s_add_u32 s57, s57, s60
s_add_u32 s57, s57, 4194304
v_lshlrev_b32 v34, 3, v0
v_mov_b32 v20, 0xbfb8aa3b
v_pk_mul_f32 v[64:65], v[64:65], v[230:231] op_sel_hi:[1,0]
v_pk_mul_f32 v[66:67], v[66:67], v[230:231] op_sel_hi:[1,0]
v_pk_mul_f32 v[68:69], v[68:69], v[230:231] op_sel_hi:[1,0]
v_pk_mul_f32 v[70:71], v[70:71], v[230:231] op_sel_hi:[1,0]
v_pk_fma_f32 v[64:65], v[228:229], v[200:201], v[64:65] op_sel_hi:[0,1,1] neg_lo:[1,0,0] neg_hi:[1,0,0]
v_pk_fma_f32 v[66:67], v[228:229], v[202:203], v[66:67] op_sel_hi:[0,1,1] neg_lo:[1,0,0] neg_hi:[1,0,0]
v_pk_fma_f32 v[68:69], v[228:229], v[204:205], v[68:69] op_sel_hi:[0,1,1] neg_lo:[1,0,0] neg_hi:[1,0,0]
v_pk_fma_f32 v[70:71], v[228:229], v[206:207], v[70:71] op_sel_hi:[0,1,1] neg_lo:[1,0,0] neg_hi:[1,0,0]
v_exp_f32 v160, v64
v_exp_f32 v161, v65
buffer_load_dwordx4 v1, s[24:27], s40 offen offset:1024 sc1 lds
v_exp_f32 v162, v66
v_exp_f32 v163, v67
v_exp_f32 v164, v68
v_exp_f32 v165, v69
v_exp_f32 v166, v70
v_exp_f32 v167, v71
v_pk_fma_f32 v[160:161], v[160:161], v[20:21], v[20:21] op_sel_hi:[1,0,0]
v_pk_fma_f32 v[162:163], v[162:163], v[20:21], v[20:21] op_sel_hi:[1,0,0]
v_pk_fma_f32 v[164:165], v[164:165], v[20:21], v[20:21] op_sel_hi:[1,0,0]
v_pk_fma_f32 v[166:167], v[166:167], v[20:21], v[20:21] op_sel_hi:[1,0,0]
v_rcp_f32 v160, v160
v_rcp_f32 v161, v161
v_rcp_f32 v162, v162
v_rcp_f32 v163, v163
v_rcp_f32 v164, v164
v_rcp_f32 v165, v165
v_rcp_f32 v166, v166
v_rcp_f32 v167, v167
buffer_load_dwordx4 v1, s[24:27], s40 offen offset:2048 sc1 lds
v_pk_mul_f32 v[64:65], v[64:65], v[160:161]
v_pk_mul_f32 v[66:67], v[66:67], v[162:163]
v_pk_mul_f32 v[68:69], v[68:69], v[164:165]
v_pk_mul_f32 v[70:71], v[70:71], v[166:167]
v_cvt_pk_bf16_f32 v120, v64, v65
v_cvt_pk_bf16_f32 v121, v66, v67
v_cvt_pk_bf16_f32 v122, v68, v69
v_cvt_pk_bf16_f32 v123, v70, v71
buffer_store_dwordx4 v[120:123], v1, s[24:27], s57 offen offset:0 sc1
v_pk_mul_f32 v[72:73], v[72:73], v[230:231] op_sel_hi:[1,0]
v_pk_mul_f32 v[74:75], v[74:75], v[230:231] op_sel_hi:[1,0]
v_pk_mul_f32 v[76:77], v[76:77], v[230:231] op_sel_hi:[1,0]
v_pk_mul_f32 v[78:79], v[78:79], v[230:231] op_sel_hi:[1,0]
v_pk_fma_f32 v[72:73], v[228:229], v[208:209], v[72:73] op_sel_hi:[0,1,1] neg_lo:[1,0,0] neg_hi:[1,0,0]
v_pk_fma_f32 v[74:75], v[228:229], v[210:211], v[74:75] op_sel_hi:[0,1,1] neg_lo:[1,0,0] neg_hi:[1,0,0]
v_pk_fma_f32 v[76:77], v[228:229], v[212:213], v[76:77] op_sel_hi:[0,1,1] neg_lo:[1,0,0] neg_hi:[1,0,0]
v_pk_fma_f32 v[78:79], v[228:229], v[214:215], v[78:79] op_sel_hi:[0,1,1] neg_lo:[1,0,0] neg_hi:[1,0,0]
v_exp_f32 v160, v72
buffer_load_dwordx4 v1, s[24:27], s40 offen offset:3072 sc1 lds
v_exp_f32 v161, v73
v_exp_f32 v162, v74
v_exp_f32 v163, v75
v_exp_f32 v164, v76
v_exp_f32 v165, v77
v_exp_f32 v166, v78
v_exp_f32 v167, v79
v_pk_fma_f32 v[160:161], v[160:161], v[20:21], v[20:21] op_sel_hi:[1,0,0]
v_pk_fma_f32 v[162:163], v[162:163], v[20:21], v[20:21] op_sel_hi:[1,0,0]
v_pk_fma_f32 v[164:165], v[164:165], v[20:21], v[20:21] op_sel_hi:[1,0,0]
v_pk_fma_f32 v[166:167], v[166:167], v[20:21], v[20:21] op_sel_hi:[1,0,0]
v_rcp_f32 v160, v160
v_rcp_f32 v161, v161
v_rcp_f32 v162, v162
v_rcp_f32 v163, v163
v_rcp_f32 v164, v164
v_rcp_f32 v165, v165
v_rcp_f32 v166, v166
s_add_u32 m0, s51, 16384
s_add_u32 s40, s73, 8192
buffer_load_dwordx4 v1, s[24:27], s40 offen offset:0 sc1 lds
v_rcp_f32 v167, v167
v_pk_mul_f32 v[72:73], v[72:73], v[160:161]
v_pk_mul_f32 v[74:75], v[74:75], v[162:163]
v_pk_mul_f32 v[76:77], v[76:77], v[164:165]
v_pk_mul_f32 v[78:79], v[78:79], v[166:167]
v_cvt_pk_bf16_f32 v124, v72, v73
v_cvt_pk_bf16_f32 v125, v74, v75
v_cvt_pk_bf16_f32 v126, v76, v77
v_cvt_pk_bf16_f32 v127, v78, v79
buffer_store_dwordx4 v[124:127], v1, s[24:27], s57 offen offset:1024 sc1
v_pk_mul_f32 v[80:81], v[80:81], v[230:231] op_sel_hi:[1,0]
v_pk_mul_f32 v[82:83], v[82:83], v[230:231] op_sel_hi:[1,0]
v_pk_mul_f32 v[84:85], v[84:85], v[230:231] op_sel_hi:[1,0]
v_pk_mul_f32 v[86:87], v[86:87], v[230:231] op_sel_hi:[1,0]
v_pk_fma_f32 v[80:81], v[228:229], v[216:217], v[80:81] op_sel_hi:[0,1,1] neg_lo:[1,0,0] neg_hi:[1,0,0]
v_pk_fma_f32 v[82:83], v[228:229], v[218:219], v[82:83] op_sel_hi:[0,1,1] neg_lo:[1,0,0] neg_hi:[1,0,0]
v_pk_fma_f32 v[84:85], v[228:229], v[220:221], v[84:85] op_sel_hi:[0,1,1] neg_lo:[1,0,0] neg_hi:[1,0,0]
v_pk_fma_f32 v[86:87], v[228:229], v[222:223], v[86:87] op_sel_hi:[0,1,1] neg_lo:[1,0,0] neg_hi:[1,0,0]
buffer_load_dwordx4 v1, s[24:27], s40 offen offset:1024 sc1 lds
v_exp_f32 v160, v80
v_exp_f32 v161, v81
v_exp_f32 v162, v82
v_exp_f32 v163, v83
v_exp_f32 v164, v84
v_exp_f32 v165, v85
v_exp_f32 v166, v86
v_exp_f32 v167, v87
v_pk_fma_f32 v[160:161], v[160:161], v[20:21], v[20:21] op_sel_hi:[1,0,0]
v_pk_fma_f32 v[162:163], v[162:163], v[20:21], v[20:21] op_sel_hi:[1,0,0]
v_pk_fma_f32 v[164:165], v[164:165], v[20:21], v[20:21] op_sel_hi:[1,0,0]
v_pk_fma_f32 v[166:167], v[166:167], v[20:21], v[20:21] op_sel_hi:[1,0,0]
v_rcp_f32 v160, v160
v_rcp_f32 v161, v161
v_rcp_f32 v162, v162
v_rcp_f32 v163, v163
v_rcp_f32 v164, v164
v_rcp_f32 v165, v165
buffer_load_dwordx4 v1, s[24:27], s40 offen offset:2048 sc1 lds
v_rcp_f32 v166, v166
v_rcp_f32 v167, v167
v_pk_mul_f32 v[80:81], v[80:81], v[160:161]
v_pk_mul_f32 v[82:83], v[82:83], v[162:163]
v_pk_mul_f32 v[84:85], v[84:85], v[164:165]
v_pk_mul_f32 v[86:87], v[86:87], v[166:167]
v_cvt_pk_bf16_f32 v128, v80, v81
v_cvt_pk_bf16_f32 v129, v82, v83
v_cvt_pk_bf16_f32 v130, v84, v85
v_cvt_pk_bf16_f32 v131, v86, v87
buffer_store_dwordx4 v[128:131], v1, s[24:27], s57 offen offset:2048 sc1
v_pk_mul_f32 v[88:89], v[88:89], v[230:231] op_sel_hi:[1,0]
v_pk_mul_f32 v[90:91], v[90:91], v[230:231] op_sel_hi:[1,0]
v_pk_fma_f32 v[88:89], v[228:229], v[224:225], v[88:89] op_sel_hi:[0,1,1] neg_lo:[1,0,0] neg_hi:[1,0,0]
v_pk_fma_f32 v[90:91], v[228:229], v[226:227], v[90:91] op_sel_hi:[0,1,1] neg_lo:[1,0,0] neg_hi:[1,0,0]
v_exp_f32 v160, v88
v_exp_f32 v161, v89
v_exp_f32 v162, v90
buffer_load_dwordx4 v1, s[24:27], s40 offen offset:3072 sc1 lds
v_exp_f32 v163, v91
v_pk_fma_f32 v[160:161], v[160:161], v[20:21], v[20:21] op_sel_hi:[1,0,0]
v_pk_fma_f32 v[162:163], v[162:163], v[20:21], v[20:21] op_sel_hi:[1,0,0]
v_rcp_f32 v160, v160
v_rcp_f32 v161, v161
v_rcp_f32 v162, v162
v_rcp_f32 v163, v163
v_pk_mul_f32 v[88:89], v[88:89], v[160:161]
v_pk_mul_f32 v[90:91], v[90:91], v[162:163]
v_cvt_pk_bf16_f32 v132, v88, v89
v_cvt_pk_bf16_f32 v133, v90, v91
buffer_store_dwordx2 v[132:133], v34, s[24:27], s57 offen offset:3072 sc1
s_add_u32 s57, s57, 57344
v_pk_mul_f32 v[92:93], v[92:93], v[234:235] op_sel_hi:[1,0]
v_pk_mul_f32 v[94:95], v[94:95], v[234:235] op_sel_hi:[1,0]
v_pk_mul_f32 v[96:97], v[96:97], v[234:235] op_sel_hi:[1,0]
v_pk_mul_f32 v[98:99], v[98:99], v[234:235] op_sel_hi:[1,0]
v_pk_fma_f32 v[92:93], v[232:233], v[200:201], v[92:93] op_sel_hi:[0,1,1] neg_lo:[1,0,0] neg_hi:[1,0,0]
s_add_u32 m0, s51, 32768
s_add_u32 s40, s74, 0
buffer_load_dwordx4 v1, s[24:27], s40 offen offset:0 sc1 lds
v_pk_fma_f32 v[94:95], v[232:233], v[202:203], v[94:95] op_sel_hi:[0,1,1] neg_lo:[1,0,0] neg_hi:[1,0,0]
v_pk_fma_f32 v[96:97], v[232:233], v[204:205], v[96:97] op_sel_hi:[0,1,1] neg_lo:[1,0,0] neg_hi:[1,0,0]
v_pk_fma_f32 v[98:99], v[232:233], v[206:207], v[98:99] op_sel_hi:[0,1,1] neg_lo:[1,0,0] neg_hi:[1,0,0]
v_exp_f32 v160, v92
v_exp_f32 v161, v93
v_exp_f32 v162, v94
v_exp_f32 v163, v95
v_exp_f32 v164, v96
v_exp_f32 v165, v97
v_exp_f32 v166, v98
v_exp_f32 v167, v99
v_pk_fma_f32 v[160:161], v[160:161], v[20:21], v[20:21] op_sel_hi:[1,0,0]
v_pk_fma_f32 v[162:163], v[162:163], v[20:21], v[20:21] op_sel_hi:[1,0,0]
v_pk_fma_f32 v[164:165], v[164:165], v[20:21], v[20:21] op_sel_hi:[1,0,0]
v_pk_fma_f32 v[166:167], v[166:167], v[20:21], v[20:21] op_sel_hi:[1,0,0]
v_rcp_f32 v160, v160
v_rcp_f32 v161, v161
v_rcp_f32 v162, v162
buffer_load_dwordx4 v1, s[24:27], s40 offen offset:1024 sc1 lds
v_rcp_f32 v163, v163
v_rcp_f32 v164, v164
v_rcp_f32 v165, v165
v_rcp_f32 v166, v166
v_rcp_f32 v167, v167
v_pk_mul_f32 v[92:93], v[92:93], v[160:161]
v_pk_mul_f32 v[94:95], v[94:95], v[162:163]
v_pk_mul_f32 v[96:97], v[96:97], v[164:165]
v_pk_mul_f32 v[98:99], v[98:99], v[166:167]
v_cvt_pk_bf16_f32 v136, v92, v93
v_cvt_pk_bf16_f32 v137, v94, v95
v_cvt_pk_bf16_f32 v138, v96, v97
v_cvt_pk_bf16_f32 v139, v98, v99
buffer_store_dwordx4 v[136:139], v1, s[24:27], s57 offen offset:0 sc1
v_pk_mul_f32 v[100:101], v[100:101], v[234:235] op_sel_hi:[1,0]
v_pk_mul_f32 v[102:103], v[102:103], v[234:235] op_sel_hi:[1,0]
v_pk_mul_f32 v[104:105], v[104:105], v[234:235] op_sel_hi:[1,0]
v_pk_mul_f32 v[106:107], v[106:107], v[234:235] op_sel_hi:[1,0]
buffer_load_dwordx4 v1, s[24:27], s40 offen offset:2048 sc1 lds
v_pk_fma_f32 v[100:101], v[232:233], v[208:209], v[100:101] op_sel_hi:[0,1,1] neg_lo:[1,0,0] neg_hi:[1,0,0]
v_pk_fma_f32 v[102:103], v[232:233], v[210:211], v[102:103] op_sel_hi:[0,1,1] neg_lo:[1,0,0] neg_hi:[1,0,0]
v_pk_fma_f32 v[104:105], v[232:233], v[212:213], v[104:105] op_sel_hi:[0,1,1] neg_lo:[1,0,0] neg_hi:[1,0,0]
v_pk_fma_f32 v[106:107], v[232:233], v[214:215], v[106:107] op_sel_hi:[0,1,1] neg_lo:[1,0,0] neg_hi:[1,0,0]
v_exp_f32 v160, v100
v_exp_f32 v161, v101
v_exp_f32 v162, v102
v_exp_f32 v163, v103
v_exp_f32 v164, v104
v_exp_f32 v165, v105
v_exp_f32 v166, v106
v_exp_f32 v167, v107
v_pk_fma_f32 v[160:161], v[160:161], v[20:21], v[20:21] op_sel_hi:[1,0,0]
v_pk_fma_f32 v[162:163], v[162:163], v[20:21], v[20:21] op_sel_hi:[1,0,0]
v_pk_fma_f32 v[164:165], v[164:165], v[20:21], v[20:21] op_sel_hi:[1,0,0]
v_pk_fma_f32 v[166:167], v[166:167], v[20:21], v[20:21] op_sel_hi:[1,0,0]
v_rcp_f32 v160, v160
v_rcp_f32 v161, v161
buffer_load_dwordx4 v1, s[24:27], s40 offen offset:3072 sc1 lds
v_rcp_f32 v162, v162
v_rcp_f32 v163, v163
v_rcp_f32 v164, v164
v_rcp_f32 v165, v165
v_rcp_f32 v166, v166
v_rcp_f32 v167, v167
v_pk_mul_f32 v[100:101], v[100:101], v[160:161]
v_pk_mul_f32 v[102:103], v[102:103], v[162:163]
v_pk_mul_f32 v[104:105], v[104:105], v[164:165]
v_pk_mul_f32 v[106:107], v[106:107], v[166:167]
v_cvt_pk_bf16_f32 v140, v100, v101
v_cvt_pk_bf16_f32 v141, v102, v103
v_cvt_pk_bf16_f32 v142, v104, v105
v_cvt_pk_bf16_f32 v143, v106, v107
buffer_store_dwordx4 v[140:143], v1, s[24:27], s57 offen offset:1024 sc1
v_pk_mul_f32 v[108:109], v[108:109], v[234:235] op_sel_hi:[1,0]
v_pk_mul_f32 v[110:111], v[110:111], v[234:235] op_sel_hi:[1,0]
v_pk_mul_f32 v[112:113], v[112:113], v[234:235] op_sel_hi:[1,0]
v_pk_mul_f32 v[114:115], v[114:115], v[234:235] op_sel_hi:[1,0]
v_pk_fma_f32 v[108:109], v[232:233], v[216:217], v[108:109] op_sel_hi:[0,1,1] neg_lo:[1,0,0] neg_hi:[1,0,0]
v_pk_fma_f32 v[110:111], v[232:233], v[218:219], v[110:111] op_sel_hi:[0,1,1] neg_lo:[1,0,0] neg_hi:[1,0,0]
v_pk_fma_f32 v[112:113], v[232:233], v[220:221], v[112:113] op_sel_hi:[0,1,1] neg_lo:[1,0,0] neg_hi:[1,0,0]
v_pk_fma_f32 v[114:115], v[232:233], v[222:223], v[114:115] op_sel_hi:[0,1,1] neg_lo:[1,0,0] neg_hi:[1,0,0]
v_exp_f32 v160, v108
v_exp_f32 v161, v109
v_exp_f32 v162, v110
v_exp_f32 v163, v111
v_exp_f32 v164, v112
v_exp_f32 v165, v113
v_exp_f32 v166, v114
v_exp_f32 v167, v115
v_pk_fma_f32 v[160:161], v[160:161], v[20:21], v[20:21] op_sel_hi:[1,0,0]
v_pk_fma_f32 v[162:163], v[162:163], v[20:21], v[20:21] op_sel_hi:[1,0,0]
v_pk_fma_f32 v[164:165], v[164:165], v[20:21], v[20:21] op_sel_hi:[1,0,0]
v_pk_fma_f32 v[166:167], v[166:167], v[20:21], v[20:21] op_sel_hi:[1,0,0]
v_rcp_f32 v160, v160
v_rcp_f32 v161, v161
v_rcp_f32 v162, v162
v_rcp_f32 v163, v163
v_rcp_f32 v164, v164
v_rcp_f32 v165, v165
v_rcp_f32 v166, v166
v_rcp_f32 v167, v167
v_pk_mul_f32 v[108:109], v[108:109], v[160:161]
v_pk_mul_f32 v[110:111], v[110:111], v[162:163]
v_pk_mul_f32 v[112:113], v[112:113], v[164:165]
v_pk_mul_f32 v[114:115], v[114:115], v[166:167]
v_cvt_pk_bf16_f32 v144, v108, v109
v_cvt_pk_bf16_f32 v145, v110, v111
v_cvt_pk_bf16_f32 v146, v112, v113
v_cvt_pk_bf16_f32 v147, v114, v115
buffer_store_dwordx4 v[144:147], v1, s[24:27], s57 offen offset:2048 sc1
v_pk_mul_f32 v[116:117], v[116:117], v[234:235] op_sel_hi:[1,0]
v_pk_mul_f32 v[118:119], v[118:119], v[234:235] op_sel_hi:[1,0]
v_pk_fma_f32 v[116:117], v[232:233], v[224:225], v[116:117] op_sel_hi:[0,1,1] neg_lo:[1,0,0] neg_hi:[1,0,0]
v_pk_fma_f32 v[118:119], v[232:233], v[226:227], v[118:119] op_sel_hi:[0,1,1] neg_lo:[1,0,0] neg_hi:[1,0,0]
v_exp_f32 v160, v116
v_exp_f32 v161, v117
v_exp_f32 v162, v118
v_exp_f32 v163, v119
v_pk_fma_f32 v[160:161], v[160:161], v[20:21], v[20:21] op_sel_hi:[1,0,0]
v_pk_fma_f32 v[162:163], v[162:163], v[20:21], v[20:21] op_sel_hi:[1,0,0]
v_rcp_f32 v160, v160
v_rcp_f32 v161, v161
v_rcp_f32 v162, v162
v_rcp_f32 v163, v163
v_pk_mul_f32 v[116:117], v[116:117], v[160:161]
v_pk_mul_f32 v[118:119], v[118:119], v[162:163]
v_cvt_pk_bf16_f32 v148, v116, v117
v_cvt_pk_bf16_f32 v149, v118, v119
buffer_store_dwordx2 v[148:149], v34, s[24:27], s57 offen offset:3072 sc1
s_add_u32 m0, s51, 49152
s_add_u32 s40, s74, 4096
buffer_load_dwordx4 v1, s[24:27], s40 offen offset:0 sc1 lds
buffer_load_dwordx4 v1, s[24:27], s40 offen offset:1024 sc1 lds
buffer_load_dwordx4 v1, s[24:27], s40 offen offset:2048 sc1 lds
buffer_load_dwordx4 v1, s[24:27], s40 offen offset:3072 sc1 lds
s_add_u32 m0, s51, 65536
s_add_u32 s40, s74, 8192
buffer_load_dwordx4 v1, s[24:27], s40 offen offset:0 sc1 lds
buffer_load_dwordx4 v1, s[24:27], s40 offen offset:1024 sc1 lds
buffer_load_dwordx4 v1, s[24:27], s40 offen offset:2048 sc1 lds
buffer_load_dwordx4 v1, s[24:27], s40 offen offset:3072 sc1 lds
s_add_u32 s61, s61, 1
s_or_b32 s57, s44, s61
v_mov_b32 v22, s57
v_mov_b32 v23, s45
s_lshl_b32 s58, s37, 3
s_cmp_lg_u32 s38, 0
s_waitcnt vmcnt(8)
s_barrier
s_cbranch_scc1 Lsig3242
s_mov_b64 exec, 1
buffer_store_dwordx2 v[22:23], v12, s[24:27], s58 offen sc1
s_mov_b64 exec, -1
Lsig3242:
s_add_u32 m0, s51, 81920
s_add_u32 s40, s75, 0
buffer_load_dwordx4 v1, s[24:27], s40 offen offset:0 sc1 lds
buffer_load_dwordx4 v1, s[24:27], s40 offen offset:1024 sc1 lds
buffer_load_dwordx4 v1, s[24:27], s40 offen offset:2048 sc1 lds
buffer_load_dwordx4 v1, s[24:27], s40 offen offset:3072 sc1 lds
s_add_u32 m0, s51, 98304
s_add_u32 s40, s75, 4096
buffer_load_dwordx4 v1, s[24:27], s40 offen offset:0 sc1 lds
buffer_load_dwordx4 v1, s[24:27], s40 offen offset:1024 sc1 lds
buffer_load_dwordx4 v1, s[24:27], s40 offen offset:2048 sc1 lds
buffer_load_dwordx4 v1, s[24:27], s40 offen offset:3072 sc1 lds
s_waitcnt lgkmcnt(0)
s_add_u32 m0, s51, 114688
s_add_u32 s40, s50, 53248
buffer_load_dwordx4 v1, s[24:27], s40 offen offset:0 sc1 lds
buffer_load_dwordx4 v1, s[24:27], s40 offen offset:1024 sc1 lds
buffer_load_dwordx4 v1, s[24:27], s40 offen offset:2048 sc1 lds
buffer_load_dwordx4 v1, s[24:27], s40 offen offset:3072 sc1 lds
s_lshr_b32 s57, s42, 14
s_sub_u32 s57, s57, s38
s_mul_i32 s57, s57, 57344
s_mul_i32 s58, s38, 14336
s_add_u32 s57, s57, s58
s_add_u32 s57, s57, s60
s_add_u32 s57, s57, 4194304
v_add_u32 v36, s57, v1
v_lshl_add_u32 v37, v0, 3, s57
s_add_u32 s57, s38, 1
s_and_b32 s57, s57, 3
s_mul_i32 s57, s57, 12288
s_add_u32 s57, s57, 98304
v_add_u32 v17, s57, v1
s_add_u32 s57, s38, 2
s_and_b32 s57, s57, 3
s_mul_i32 s57, s57, 12288
s_add_u32 s57, s57, 102400
v_add_u32 v18, s57, v1
s_add_u32 s57, s38, 3
s_and_b32 s57, s57, 3
s_mul_i32 s57, s57, 12288
s_add_u32 s57, s57, 106496
v_add_u32 v19, s57, v1
s_mul_i32 s57, s38, 12288
s_add_u32 s57, s57, 98304
v_add_u32 v20, s57, v1
s_cmp_lg_u32 s38, 0
s_cbranch_scc1 Lpoll3301x
s_mov_b32 s98, 0x40000
s_or_b32 s57, s44, s61
s_sub_u32 s58, 16, s61
Lpoll3301:
buffer_load_dwordx2 v[248:249], v12, s[24:27], 0 offen sc1
Lpoll3301p:
s_sub_u32 s98, s98, 1
s_cbranch_scc1 Lend
s_waitcnt vmcnt(0)
v_subrev_u32 v248, s57, v248
v_xor_b32 v249, s45, v249
v_cmp_gt_u32 vcc, s58, v248
v_cmp_eq_u32 s[2:3], 0, v249
s_nop 1
s_and_b64 vcc, vcc, s[2:3]
s_cmp_eq_u64 vcc, exec
s_cbranch_scc1 Lpoll3301x
s_sleep 6
s_branch Lpoll3301
Lpoll3301x:
s_waitcnt vmcnt(0) lgkmcnt(0)
s_barrier
s_add_u32 s41, s56, s76
buffer_load_dwordx4 a[0:3], v36, s[24:27], s41 offen offset:0 sc1
s_add_u32 s41, s99, s76
buffer_load_dwordx4 a[4:7], v36, s[24:27], s41 offen offset:0 sc1
s_add_u32 s41, s100, s76
buffer_load_dwordx4 a[8:11], v36, s[24:27], s41 offen offset:0 sc1
s_add_u32 s41, s101, s76
buffer_load_dwordx4 a[12:15], v36, s[24:27], s41 offen offset:0 sc1
s_add_u32 s41, s56, s76
buffer_load_dwordx4 a[16:19], v36, s[24:27], s41 offen offset:1024 sc1
s_add_u32 s41, s99, s76
buffer_load_dwordx4 a[20:23], v36, s[24:27], s41 offen offset:1024 sc1
s_add_u32 s41, s100, s76
buffer_load_dwordx4 a[24:27], v36, s[24:27], s41 offen offset:1024 sc1
s_add_u32 s41, s101, s76
buffer_load_dwordx4 a[28:31], v36, s[24:27], s41 offen offset:1024 sc1
s_add_u32 s41, s56, s76
buffer_load_dwordx4 a[32:35], v36, s[24:27], s41 offen offset:2048 sc1
s_add_u32 s41, s99, s76
buffer_load_dwordx4 a[36:39], v36, s[24:27], s41 offen offset:2048 sc1
s_add_u32 s41, s100, s76
buffer_load_dwordx4 a[40:43], v36, s[24:27], s41 offen offset:2048 sc1
s_add_u32 s41, s101, s76
buffer_load_dwordx4 a[44:47], v36, s[24:27], s41 offen offset:2048 sc1
s_waitcnt vmcnt(8) lgkmcnt(0)
v_mfma_f32_16x16x32_bf16 v[64:67], a[128:131], a[0:3], 0
s_add_u32 s41, s56, s77
buffer_load_dwordx4 a[48:51], v36, s[24:27], s41 offen offset:0 sc1
v_mfma_f32_16x16x32_bf16 v[80:83], a[128:131], a[4:7], 0
v_mfma_f32_16x16x32_bf16 v[96:99], a[128:131], a[8:11], 0
s_add_u32 s41, s99, s77
buffer_load_dwordx4 a[52:55], v36, s[24:27], s41 offen offset:0 sc1
v_mfma_f32_16x16x32_bf16 v[112:115], a[128:131], a[12:15], 0
v_mfma_f32_16x16x32_bf16 v[68:71], a[132:135], a[0:3], 0
s_add_u32 s41, s100, s77
buffer_load_dwordx4 a[56:59], v36, s[24:27], s41 offen offset:0 sc1
v_mfma_f32_16x16x32_bf16 v[84:87], a[132:135], a[4:7], 0
v_mfma_f32_16x16x32_bf16 v[100:103], a[132:135], a[8:11], 0
s_add_u32 s41, s101, s77
buffer_load_dwordx4 a[60:63], v36, s[24:27], s41 offen offset:0 sc1
v_mfma_f32_16x16x32_bf16 v[116:119], a[132:135], a[12:15], 0
v_mfma_f32_16x16x32_bf16 v[72:75], a[136:139], a[0:3], 0
s_add_u32 s41, s56, s77
buffer_load_dwordx4 a[64:67], v36, s[24:27], s41 offen offset:1024 sc1
v_mfma_f32_16x16x32_bf16 v[88:91], a[136:139], a[4:7], 0
v_mfma_f32_16x16x32_bf16 v[104:107], a[136:139], a[8:11], 0
s_add_u32 s41, s99, s77
buffer_load_dwordx4 a[68:71], v36, s[24:27], s41 offen offset:1024 sc1
v_mfma_f32_16x16x32_bf16 v[120:123], a[136:139], a[12:15], 0
v_mfma_f32_16x16x32_bf16 v[76:79], a[140:143], a[0:3], 0
s_add_u32 s41, s100, s77
buffer_load_dwordx4 a[72:75], v36, s[24:27], s41 offen offset:1024 sc1
v_mfma_f32_16x16x32_bf16 v[92:95], a[140:143], a[4:7], 0
v_mfma_f32_16x16x32_bf16 v[108:111], a[140:143], a[8:11], 0
s_add_u32 s41, s101, s77
buffer_load_dwordx4 a[76:79], v36, s[24:27], s41 offen offset:1024 sc1
v_mfma_f32_16x16x32_bf16 v[124:127], a[140:143], a[12:15], 0
s_waitcnt vmcnt(12) lgkmcnt(0)
v_mfma_f32_16x16x32_bf16 v[64:67], a[144:147], a[16:19], v[64:67]
s_add_u32 s41, s56, s77
buffer_load_dwordx4 a[80:83], v36, s[24:27], s41 offen offset:2048 sc1
v_mfma_f32_16x16x32_bf16 v[80:83], a[144:147], a[20:23], v[80:83]
v_mfma_f32_16x16x32_bf16 v[96:99], a[144:147], a[24:27], v[96:99]
v_mfma_f32_16x16x32_bf16 v[112:115], a[144:147], a[28:31], v[112:115]
v_mfma_f32_16x16x32_bf16 v[68:71], a[148:151], a[16:19], v[68:71]
s_add_u32 s41, s99, s77
buffer_load_dwordx4 a[84:87], v36, s[24:27], s41 offen offset:2048 sc1
v_mfma_f32_16x16x32_bf16 v[84:87], a[148:151], a[20:23], v[84:87]
v_mfma_f32_16x16x32_bf16 v[100:103], a[148:151], a[24:27], v[100:103]
v_mfma_f32_16x16x32_bf16 v[116:119], a[148:151], a[28:31], v[116:119]
v_mfma_f32_16x16x32_bf16 v[72:75], a[152:155], a[16:19], v[72:75]
s_add_u32 s41, s100, s77
buffer_load_dwordx4 a[88:91], v36, s[24:27], s41 offen offset:2048 sc1
v_mfma_f32_16x16x32_bf16 v[88:91], a[152:155], a[20:23], v[88:91]
v_mfma_f32_16x16x32_bf16 v[104:107], a[152:155], a[24:27], v[104:107]
v_mfma_f32_16x16x32_bf16 v[120:123], a[152:155], a[28:31], v[120:123]
v_mfma_f32_16x16x32_bf16 v[76:79], a[156:159], a[16:19], v[76:79]
s_add_u32 s41, s101, s77
buffer_load_dwordx4 a[92:95], v36, s[24:27], s41 offen offset:2048 sc1
v_mfma_f32_16x16x32_bf16 v[92:95], a[156:159], a[20:23], v[92:95]
v_mfma_f32_16x16x32_bf16 v[108:111], a[156:159], a[24:27], v[108:111]
v_mfma_f32_16x16x32_bf16 v[124:127], a[156:159], a[28:31], v[124:127]
s_waitcnt vmcnt(12) lgkmcnt(0)
v_mfma_f32_16x16x32_bf16 v[64:67], a[160:163], a[32:35], v[64:67]
s_add_u32 s41, s56, s78
buffer_load_dwordx4 a[96:99], v36, s[24:27], s41 offen offset:0 sc1
v_mfma_f32_16x16x32_bf16 v[80:83], a[160:163], a[36:39], v[80:83]
v_mfma_f32_16x16x32_bf16 v[96:99], a[160:163], a[40:43], v[96:99]
v_mfma_f32_16x16x32_bf16 v[112:115], a[160:163], a[44:47], v[112:115]
v_mfma_f32_16x16x32_bf16 v[68:71], a[164:167], a[32:35], v[68:71]
s_add_u32 s41, s99, s78
buffer_load_dwordx4 a[100:103], v36, s[24:27], s41 offen offset:0 sc1
v_mfma_f32_16x16x32_bf16 v[84:87], a[164:167], a[36:39], v[84:87]
v_mfma_f32_16x16x32_bf16 v[100:103], a[164:167], a[40:43], v[100:103]
v_mfma_f32_16x16x32_bf16 v[116:119], a[164:167], a[44:47], v[116:119]
v_mfma_f32_16x16x32_bf16 v[72:75], a[168:171], a[32:35], v[72:75]
s_add_u32 s41, s100, s78
buffer_load_dwordx4 a[104:107], v36, s[24:27], s41 offen offset:0 sc1
v_mfma_f32_16x16x32_bf16 v[88:91], a[168:171], a[36:39], v[88:91]
v_mfma_f32_16x16x32_bf16 v[104:107], a[168:171], a[40:43], v[104:107]
v_mfma_f32_16x16x32_bf16 v[120:123], a[168:171], a[44:47], v[120:123]
v_mfma_f32_16x16x32_bf16 v[76:79], a[172:175], a[32:35], v[76:79]
s_add_u32 s41, s101, s78
buffer_load_dwordx4 a[108:111], v36, s[24:27], s41 offen offset:0 sc1
v_mfma_f32_16x16x32_bf16 v[92:95], a[172:175], a[36:39], v[92:95]
v_mfma_f32_16x16x32_bf16 v[108:111], a[172:175], a[40:43], v[108:111]
v_mfma_f32_16x16x32_bf16 v[124:127], a[172:175], a[44:47], v[124:127]
s_waitcnt vmcnt(12) lgkmcnt(0)
v_mfma_f32_16x16x32_bf16 v[64:67], a[176:179], a[48:51], v[64:67]
ds_read_b64_tr_b16 v[216:217], v40 offset:0
s_add_u32 s41, s56, s78
buffer_load_dwordx4 a[112:115], v36, s[24:27], s41 offen offset:1024 sc1
v_mfma_f32_16x16x32_bf16 v[80:83], a[176:179], a[52:55], v[80:83]
v_mfma_f32_16x16x32_bf16 v[96:99], a[176:179], a[56:59], v[96:99]
ds_read_b64_tr_b16 v[218:219], v40 offset:2048
v_mfma_f32_16x16x32_bf16 v[112:115], a[176:179], a[60:63], v[112:115]
v_mfma_f32_16x16x32_bf16 v[68:71], a[180:183], a[48:51], v[68:71]
ds_read_b64_tr_b16 v[220:221], v41 offset:0
s_add_u32 s41, s99, s78
buffer_load_dwordx4 a[116:119], v36, s[24:27], s41 offen offset:1024 sc1
v_mfma_f32_16x16x32_bf16 v[84:87], a[180:183], a[52:55], v[84:87]
v_mfma_f32_16x16x32_bf16 v[100:103], a[180:183], a[56:59], v[100:103]
ds_read_b64_tr_b16 v[222:223], v41 offset:2048
v_mfma_f32_16x16x32_bf16 v[116:119], a[180:183], a[60:63], v[116:119]
v_mfma_f32_16x16x32_bf16 v[72:75], a[184:187], a[48:51], v[72:75]
ds_read_b64_tr_b16 v[224:225], v42 offset:0
s_add_u32 s41, s100, s78
buffer_load_dwordx4 a[120:123], v36, s[24:27], s41 offen offset:1024 sc1
v_mfma_f32_16x16x32_bf16 v[88:91], a[184:187], a[52:55], v[88:91]
v_mfma_f32_16x16x32_bf16 v[104:107], a[184:187], a[56:59], v[104:107]
ds_read_b64_tr_b16 v[226:227], v42 offset:2048
v_mfma_f32_16x16x32_bf16 v[120:123], a[184:187], a[60:63], v[120:123]
v_mfma_f32_16x16x32_bf16 v[76:79], a[188:191], a[48:51], v[76:79]
ds_read_b64_tr_b16 v[228:229], v43 offset:0
s_add_u32 s41, s101, s78
buffer_load_dwordx4 a[124:127], v36, s[24:27], s41 offen offset:1024 sc1
v_mfma_f32_16x16x32_bf16 v[92:95], a[188:191], a[52:55], v[92:95]
v_mfma_f32_16x16x32_bf16 v[108:111], a[188:191], a[56:59], v[108:111]
ds_read_b64_tr_b16 v[230:231], v43 offset:2048
v_mfma_f32_16x16x32_bf16 v[124:127], a[188:191], a[60:63], v[124:127]
s_waitcnt vmcnt(12) lgkmcnt(4)
v_mfma_f32_16x16x32_bf16 v[64:67], v[216:219], a[64:67], v[64:67]
ds_read_b64_tr_b16 v[232:233], v40 offset:16384
s_add_u32 s41, s56, s78
buffer_load_dwordx4 a[0:3], v36, s[24:27], s41 offen offset:2048 sc1
v_mfma_f32_16x16x32_bf16 v[80:83], v[216:219], a[68:71], v[80:83]
v_mfma_f32_16x16x32_bf16 v[96:99], v[216:219], a[72:75], v[96:99]
ds_read_b64_tr_b16 v[234:235], v40 offset:18432
v_mfma_f32_16x16x32_bf16 v[112:115], v[216:219], a[76:79], v[112:115]
v_mfma_f32_16x16x32_bf16 v[68:71], v[220:223], a[64:67], v[68:71]
ds_read_b64_tr_b16 v[236:237], v41 offset:16384
s_add_u32 s41, s99, s78
buffer_load_dwordx4 a[4:7], v36, s[24:27], s41 offen offset:2048 sc1
v_mfma_f32_16x16x32_bf16 v[84:87], v[220:223], a[68:71], v[84:87]
v_mfma_f32_16x16x32_bf16 v[100:103], v[220:223], a[72:75], v[100:103]
ds_read_b64_tr_b16 v[238:239], v41 offset:18432
v_mfma_f32_16x16x32_bf16 v[116:119], v[220:223], a[76:79], v[116:119]
s_waitcnt lgkmcnt(4)
v_mfma_f32_16x16x32_bf16 v[72:75], v[224:227], a[64:67], v[72:75]
ds_read_b64_tr_b16 v[240:241], v42 offset:16384
s_add_u32 s41, s100, s78
buffer_load_dwordx4 a[8:11], v36, s[24:27], s41 offen offset:2048 sc1
v_mfma_f32_16x16x32_bf16 v[88:91], v[224:227], a[68:71], v[88:91]
v_mfma_f32_16x16x32_bf16 v[104:107], v[224:227], a[72:75], v[104:107]
ds_read_b64_tr_b16 v[242:243], v42 offset:18432
v_mfma_f32_16x16x32_bf16 v[120:123], v[224:227], a[76:79], v[120:123]
v_mfma_f32_16x16x32_bf16 v[76:79], v[228:231], a[64:67], v[76:79]
ds_read_b64_tr_b16 v[244:245], v43 offset:16384
s_add_u32 s41, s101, s78
buffer_load_dwordx4 a[12:15], v36, s[24:27], s41 offen offset:2048 sc1
v_mfma_f32_16x16x32_bf16 v[92:95], v[228:231], a[68:71], v[92:95]
v_mfma_f32_16x16x32_bf16 v[108:111], v[228:231], a[72:75], v[108:111]
ds_read_b64_tr_b16 v[246:247], v43 offset:18432
v_mfma_f32_16x16x32_bf16 v[124:127], v[228:231], a[76:79], v[124:127]
s_waitcnt vmcnt(12) lgkmcnt(4)
v_mfma_f32_16x16x32_bf16 v[64:67], v[232:235], a[80:83], v[64:67]
ds_read_b64_tr_b16 v[216:217], v40 offset:32768
s_add_u32 s41, s56, s79
buffer_load_dwordx4 a[16:19], v36, s[24:27], s41 offen offset:0 sc1
v_mfma_f32_16x16x32_bf16 v[80:83], v[232:235], a[84:87], v[80:83]
v_mfma_f32_16x16x32_bf16 v[96:99], v[232:235], a[88:91], v[96:99]
ds_read_b64_tr_b16 v[218:219], v40 offset:34816
v_mfma_f32_16x16x32_bf16 v[112:115], v[232:235], a[92:95], v[112:115]
v_mfma_f32_16x16x32_bf16 v[68:71], v[236:239], a[80:83], v[68:71]
ds_read_b64_tr_b16 v[220:221], v41 offset:32768
s_add_u32 s41, s99, s79
buffer_load_dwordx4 a[20:23], v36, s[24:27], s41 offen offset:0 sc1
v_mfma_f32_16x16x32_bf16 v[84:87], v[236:239], a[84:87], v[84:87]
v_mfma_f32_16x16x32_bf16 v[100:103], v[236:239], a[88:91], v[100:103]
ds_read_b64_tr_b16 v[222:223], v41 offset:34816
v_mfma_f32_16x16x32_bf16 v[116:119], v[236:239], a[92:95], v[116:119]
s_waitcnt lgkmcnt(4)
v_mfma_f32_16x16x32_bf16 v[72:75], v[240:243], a[80:83], v[72:75]
ds_read_b64_tr_b16 v[224:225], v42 offset:32768
s_add_u32 s41, s100, s79
buffer_load_dwordx4 a[24:27], v36, s[24:27], s41 offen offset:0 sc1
v_mfma_f32_16x16x32_bf16 v[88:91], v[240:243], a[84:87], v[88:91]
v_mfma_f32_16x16x32_bf16 v[104:107], v[240:243], a[88:91], v[104:107]
ds_read_b64_tr_b16 v[226:227], v42 offset:34816
v_mfma_f32_16x16x32_bf16 v[120:123], v[240:243], a[92:95], v[120:123]
v_mfma_f32_16x16x32_bf16 v[76:79], v[244:247], a[80:83], v[76:79]
ds_read_b64_tr_b16 v[228:229], v43 offset:32768
s_add_u32 s41, s101, s79
buffer_load_dwordx4 a[28:31], v36, s[24:27], s41 offen offset:0 sc1
v_mfma_f32_16x16x32_bf16 v[92:95], v[244:247], a[84:87], v[92:95]
v_mfma_f32_16x16x32_bf16 v[108:111], v[244:247], a[88:91], v[108:111]
ds_read_b64_tr_b16 v[230:231], v43 offset:34816
v_mfma_f32_16x16x32_bf16 v[124:127], v[244:247], a[92:95], v[124:127]
s_waitcnt vmcnt(12) lgkmcnt(4)
v_mfma_f32_16x16x32_bf16 v[64:67], v[216:219], a[96:99], v[64:67]
ds_read_b64_tr_b16 v[232:233], v40 offset:49152
s_add_u32 s41, s56, s79
buffer_load_dwordx4 a[32:35], v36, s[24:27], s41 offen offset:1024 sc1
v_mfma_f32_16x16x32_bf16 v[80:83], v[216:219], a[100:103], v[80:83]
v_mfma_f32_16x16x32_bf16 v[96:99], v[216:219], a[104:107], v[96:99]
ds_read_b64_tr_b16 v[234:235], v40 offset:51200
v_mfma_f32_16x16x32_bf16 v[112:115], v[216:219], a[108:111], v[112:115]
v_mfma_f32_16x16x32_bf16 v[68:71], v[220:223], a[96:99], v[68:71]
ds_read_b64_tr_b16 v[236:237], v41 offset:49152
s_add_u32 s41, s99, s79
buffer_load_dwordx4 a[36:39], v36, s[24:27], s41 offen offset:1024 sc1
v_mfma_f32_16x16x32_bf16 v[84:87], v[220:223], a[100:103], v[84:87]
v_mfma_f32_16x16x32_bf16 v[100:103], v[220:223], a[104:107], v[100:103]
ds_read_b64_tr_b16 v[238:239], v41 offset:51200
v_mfma_f32_16x16x32_bf16 v[116:119], v[220:223], a[108:111], v[116:119]
s_waitcnt lgkmcnt(4)
v_mfma_f32_16x16x32_bf16 v[72:75], v[224:227], a[96:99], v[72:75]
ds_read_b64_tr_b16 v[240:241], v42 offset:49152
s_add_u32 s41, s100, s79
buffer_load_dwordx4 a[40:43], v36, s[24:27], s41 offen offset:1024 sc1
v_mfma_f32_16x16x32_bf16 v[88:91], v[224:227], a[100:103], v[88:91]
v_mfma_f32_16x16x32_bf16 v[104:107], v[224:227], a[104:107], v[104:107]
ds_read_b64_tr_b16 v[242:243], v42 offset:51200
v_mfma_f32_16x16x32_bf16 v[120:123], v[224:227], a[108:111], v[120:123]
v_mfma_f32_16x16x32_bf16 v[76:79], v[228:231], a[96:99], v[76:79]
ds_read_b64_tr_b16 v[244:245], v43 offset:49152
s_add_u32 s41, s101, s79
buffer_load_dwordx4 a[44:47], v36, s[24:27], s41 offen offset:1024 sc1
v_mfma_f32_16x16x32_bf16 v[92:95], v[228:231], a[100:103], v[92:95]
v_mfma_f32_16x16x32_bf16 v[108:111], v[228:231], a[104:107], v[108:111]
ds_read_b64_tr_b16 v[246:247], v43 offset:51200
v_mfma_f32_16x16x32_bf16 v[124:127], v[228:231], a[108:111], v[124:127]
s_waitcnt vmcnt(12) lgkmcnt(4)
v_mfma_f32_16x16x32_bf16 v[64:67], v[232:235], a[112:115], v[64:67]
ds_read_b64_tr_b16 v[216:217], v44 offset:0
s_add_u32 s41, s56, s79
buffer_load_dwordx4 a[48:51], v36, s[24:27], s41 offen offset:2048 sc1
v_mfma_f32_16x16x32_bf16 v[80:83], v[232:235], a[116:119], v[80:83]
v_mfma_f32_16x16x32_bf16 v[96:99], v[232:235], a[120:123], v[96:99]
ds_read_b64_tr_b16 v[218:219], v44 offset:2048
v_mfma_f32_16x16x32_bf16 v[112:115], v[232:235], a[124:127], v[112:115]
v_mfma_f32_16x16x32_bf16 v[68:71], v[236:239], a[112:115], v[68:71]
ds_read_b64_tr_b16 v[220:221], v45 offset:0
s_add_u32 s41, s99, s79
buffer_load_dwordx4 a[52:55], v36, s[24:27], s41 offen offset:2048 sc1
v_mfma_f32_16x16x32_bf16 v[84:87], v[236:239], a[116:119], v[84:87]
v_mfma_f32_16x16x32_bf16 v[100:103], v[236:239], a[120:123], v[100:103]
ds_read_b64_tr_b16 v[222:223], v45 offset:2048
v_mfma_f32_16x16x32_bf16 v[116:119], v[236:239], a[124:127], v[116:119]
s_waitcnt lgkmcnt(4)
v_mfma_f32_16x16x32_bf16 v[72:75], v[240:243], a[112:115], v[72:75]
ds_read_b64_tr_b16 v[224:225], v46 offset:0
s_add_u32 s41, s100, s79
buffer_load_dwordx4 a[56:59], v36, s[24:27], s41 offen offset:2048 sc1
v_mfma_f32_16x16x32_bf16 v[88:91], v[240:243], a[116:119], v[88:91]
v_mfma_f32_16x16x32_bf16 v[104:107], v[240:243], a[120:123], v[104:107]
ds_read_b64_tr_b16 v[226:227], v46 offset:2048
v_mfma_f32_16x16x32_bf16 v[120:123], v[240:243], a[124:127], v[120:123]
v_mfma_f32_16x16x32_bf16 v[76:79], v[244:247], a[112:115], v[76:79]
ds_read_b64_tr_b16 v[228:229], v47 offset:0
s_add_u32 s41, s101, s79
buffer_load_dwordx4 a[60:63], v36, s[24:27], s41 offen offset:2048 sc1
v_mfma_f32_16x16x32_bf16 v[92:95], v[244:247], a[116:119], v[92:95]
v_mfma_f32_16x16x32_bf16 v[108:111], v[244:247], a[120:123], v[108:111]
ds_read_b64_tr_b16 v[230:231], v47 offset:2048
v_mfma_f32_16x16x32_bf16 v[124:127], v[244:247], a[124:127], v[124:127]
s_waitcnt vmcnt(12) lgkmcnt(4)
v_mfma_f32_16x16x32_bf16 v[64:67], v[216:219], a[0:3], v[64:67]
ds_read_b64_tr_b16 v[232:233], v44 offset:16384
s_add_u32 s41, s56, 0
buffer_load_dwordx2 a[64:65], v37, s[24:27], s41 offen offset:3072 sc1
v_mfma_f32_16x16x32_bf16 v[80:83], v[216:219], a[4:7], v[80:83]
v_mfma_f32_16x16x32_bf16 v[96:99], v[216:219], a[8:11], v[96:99]
ds_read_b64_tr_b16 v[234:235], v44 offset:18432
s_add_u32 s41, s56, 3584
buffer_load_dwordx2 a[66:67], v37, s[24:27], s41 offen offset:3072 sc1
v_mfma_f32_16x16x32_bf16 v[112:115], v[216:219], a[12:15], v[112:115]
v_mfma_f32_16x16x32_bf16 v[68:71], v[220:223], a[0:3], v[68:71]
ds_read_b64_tr_b16 v[236:237], v45 offset:16384
s_add_u32 s41, s99, 0
buffer_load_dwordx2 a[68:69], v37, s[24:27], s41 offen offset:3072 sc1
v_mfma_f32_16x16x32_bf16 v[84:87], v[220:223], a[4:7], v[84:87]
v_mfma_f32_16x16x32_bf16 v[100:103], v[220:223], a[8:11], v[100:103]
ds_read_b64_tr_b16 v[238:239], v45 offset:18432
s_add_u32 s41, s99, 3584
buffer_load_dwordx2 a[70:71], v37, s[24:27], s41 offen offset:3072 sc1
v_mfma_f32_16x16x32_bf16 v[116:119], v[220:223], a[12:15], v[116:119]
s_waitcnt lgkmcnt(4)
v_mfma_f32_16x16x32_bf16 v[72:75], v[224:227], a[0:3], v[72:75]
ds_read_b64_tr_b16 v[240:241], v46 offset:16384
s_add_u32 s41, s100, 0
buffer_load_dwordx2 a[72:73], v37, s[24:27], s41 offen offset:3072 sc1
v_mfma_f32_16x16x32_bf16 v[88:91], v[224:227], a[4:7], v[88:91]
v_mfma_f32_16x16x32_bf16 v[104:107], v[224:227], a[8:11], v[104:107]
ds_read_b64_tr_b16 v[242:243], v46 offset:18432
s_add_u32 s41, s100, 3584
buffer_load_dwordx2 a[74:75], v37, s[24:27], s41 offen offset:3072 sc1
v_mfma_f32_16x16x32_bf16 v[120:123], v[224:227], a[12:15], v[120:123]
v_mfma_f32_16x16x32_bf16 v[76:79], v[228:231], a[0:3], v[76:79]
ds_read_b64_tr_b16 v[244:245], v47 offset:16384
s_add_u32 s41, s101, 0
buffer_load_dwordx2 a[76:77], v37, s[24:27], s41 offen offset:3072 sc1
v_mfma_f32_16x16x32_bf16 v[92:95], v[228:231], a[4:7], v[92:95]
v_mfma_f32_16x16x32_bf16 v[108:111], v[228:231], a[8:11], v[108:111]
ds_read_b64_tr_b16 v[246:247], v47 offset:18432
s_add_u32 s41, s101, 3584
buffer_load_dwordx2 a[78:79], v37, s[24:27], s41 offen offset:3072 sc1
v_mfma_f32_16x16x32_bf16 v[124:127], v[228:231], a[12:15], v[124:127]
s_waitcnt vmcnt(16) lgkmcnt(4)
v_mfma_f32_16x16x32_bf16 v[64:67], v[232:235], a[16:19], v[64:67]
ds_read_b64_tr_b16 v[216:217], v44 offset:32768
s_add_u32 s41, s56, 7168
buffer_load_dwordx2 a[80:81], v37, s[24:27], s41 offen offset:3072 sc1
v_mfma_f32_16x16x32_bf16 v[80:83], v[232:235], a[20:23], v[80:83]
v_mfma_f32_16x16x32_bf16 v[96:99], v[232:235], a[24:27], v[96:99]
ds_read_b64_tr_b16 v[218:219], v44 offset:34816
s_add_u32 s41, s56, 10752
buffer_load_dwordx2 a[82:83], v37, s[24:27], s41 offen offset:3072 sc1
v_mfma_f32_16x16x32_bf16 v[112:115], v[232:235], a[28:31], v[112:115]
v_mfma_f32_16x16x32_bf16 v[68:71], v[236:239], a[16:19], v[68:71]
ds_read_b64_tr_b16 v[220:221], v45 offset:32768
s_add_u32 s41, s99, 7168
buffer_load_dwordx2 a[84:85], v37, s[24:27], s41 offen offset:3072 sc1
v_mfma_f32_16x16x32_bf16 v[84:87], v[236:239], a[20:23], v[84:87]
v_mfma_f32_16x16x32_bf16 v[100:103], v[236:239], a[24:27], v[100:103]
ds_read_b64_tr_b16 v[222:223], v45 offset:34816
s_add_u32 s41, s99, 10752
buffer_load_dwordx2 a[86:87], v37, s[24:27], s41 offen offset:3072 sc1
v_mfma_f32_16x16x32_bf16 v[116:119], v[236:239], a[28:31], v[116:119]
s_waitcnt lgkmcnt(4)
v_mfma_f32_16x16x32_bf16 v[72:75], v[240:243], a[16:19], v[72:75]
ds_read_b64_tr_b16 v[224:225], v46 offset:32768
s_add_u32 s41, s100, 7168
buffer_load_dwordx2 a[88:89], v37, s[24:27], s41 offen offset:3072 sc1
v_mfma_f32_16x16x32_bf16 v[88:91], v[240:243], a[20:23], v[88:91]
v_mfma_f32_16x16x32_bf16 v[104:107], v[240:243], a[24:27], v[104:107]
ds_read_b64_tr_b16 v[226:227], v46 offset:34816
s_add_u32 s41, s100, 10752
buffer_load_dwordx2 a[90:91], v37, s[24:27], s41 offen offset:3072 sc1
v_mfma_f32_16x16x32_bf16 v[120:123], v[240:243], a[28:31], v[120:123]
v_mfma_f32_16x16x32_bf16 v[76:79], v[244:247], a[16:19], v[76:79]
ds_read_b64_tr_b16 v[228:229], v47 offset:32768
s_add_u32 s41, s101, 7168
buffer_load_dwordx2 a[92:93], v37, s[24:27], s41 offen offset:3072 sc1
v_mfma_f32_16x16x32_bf16 v[92:95], v[244:247], a[20:23], v[92:95]
v_mfma_f32_16x16x32_bf16 v[108:111], v[244:247], a[24:27], v[108:111]
ds_read_b64_tr_b16 v[230:231], v47 offset:34816
s_add_u32 s41, s101, 10752
buffer_load_dwordx2 a[94:95], v37, s[24:27], s41 offen offset:3072 sc1
v_mfma_f32_16x16x32_bf16 v[124:127], v[244:247], a[28:31], v[124:127]
s_waitcnt vmcnt(20) lgkmcnt(4)
v_mfma_f32_16x16x32_bf16 v[64:67], v[216:219], a[32:35], v[64:67]
ds_read_b64_tr_b16 v[232:233], v48 offset:0
v_mfma_f32_16x16x32_bf16 v[80:83], v[216:219], a[36:39], v[80:83]
v_mfma_f32_16x16x32_bf16 v[96:99], v[216:219], a[40:43], v[96:99]
ds_read_b64_tr_b16 v[234:235], v48 offset:2048
v_mfma_f32_16x16x32_bf16 v[112:115], v[216:219], a[44:47], v[112:115]
v_mfma_f32_16x16x32_bf16 v[68:71], v[220:223], a[32:35], v[68:71]
ds_read_b64_tr_b16 v[236:237], v49 offset:0
v_mfma_f32_16x16x32_bf16 v[84:87], v[220:223], a[36:39], v[84:87]
v_mfma_f32_16x16x32_bf16 v[100:103], v[220:223], a[40:43], v[100:103]
ds_read_b64_tr_b16 v[238:239], v49 offset:2048
v_mfma_f32_16x16x32_bf16 v[116:119], v[220:223], a[44:47], v[116:119]
s_waitcnt lgkmcnt(4)
v_mfma_f32_16x16x32_bf16 v[72:75], v[224:227], a[32:35], v[72:75]
ds_read_b64_tr_b16 v[240:241], v50 offset:0
v_mfma_f32_16x16x32_bf16 v[88:91], v[224:227], a[36:39], v[88:91]
v_mfma_f32_16x16x32_bf16 v[104:107], v[224:227], a[40:43], v[104:107]
ds_read_b64_tr_b16 v[242:243], v50 offset:2048
v_mfma_f32_16x16x32_bf16 v[120:123], v[224:227], a[44:47], v[120:123]
v_mfma_f32_16x16x32_bf16 v[76:79], v[228:231], a[32:35], v[76:79]
ds_read_b64_tr_b16 v[244:245], v51 offset:0
v_mfma_f32_16x16x32_bf16 v[92:95], v[228:231], a[36:39], v[92:95]
v_mfma_f32_16x16x32_bf16 v[108:111], v[228:231], a[40:43], v[108:111]
ds_read_b64_tr_b16 v[246:247], v51 offset:2048
v_mfma_f32_16x16x32_bf16 v[124:127], v[228:231], a[44:47], v[124:127]
s_waitcnt vmcnt(16) lgkmcnt(4)
v_mfma_f32_16x16x32_bf16 v[64:67], v[232:235], a[48:51], v[64:67]
ds_read_b64_tr_b16 v[216:217], v48 offset:16384
v_mfma_f32_16x16x32_bf16 v[80:83], v[232:235], a[52:55], v[80:83]
v_mfma_f32_16x16x32_bf16 v[96:99], v[232:235], a[56:59], v[96:99]
ds_read_b64_tr_b16 v[218:219], v48 offset:18432
v_mfma_f32_16x16x32_bf16 v[112:115], v[232:235], a[60:63], v[112:115]
v_mfma_f32_16x16x32_bf16 v[68:71], v[236:239], a[48:51], v[68:71]
ds_read_b64_tr_b16 v[220:221], v49 offset:16384
v_mfma_f32_16x16x32_bf16 v[84:87], v[236:239], a[52:55], v[84:87]
v_mfma_f32_16x16x32_bf16 v[100:103], v[236:239], a[56:59], v[100:103]
ds_read_b64_tr_b16 v[222:223], v49 offset:18432
v_mfma_f32_16x16x32_bf16 v[116:119], v[236:239], a[60:63], v[116:119]
s_waitcnt lgkmcnt(4)
v_mfma_f32_16x16x32_bf16 v[72:75], v[240:243], a[48:51], v[72:75]
ds_read_b64_tr_b16 v[224:225], v50 offset:16384
v_mfma_f32_16x16x32_bf16 v[88:91], v[240:243], a[52:55], v[88:91]
v_mfma_f32_16x16x32_bf16 v[104:107], v[240:243], a[56:59], v[104:107]
ds_read_b64_tr_b16 v[226:227], v50 offset:18432
v_mfma_f32_16x16x32_bf16 v[120:123], v[240:243], a[60:63], v[120:123]
v_mfma_f32_16x16x32_bf16 v[76:79], v[244:247], a[48:51], v[76:79]
ds_read_b64_tr_b16 v[228:229], v51 offset:16384
v_mfma_f32_16x16x32_bf16 v[92:95], v[244:247], a[52:55], v[92:95]
v_mfma_f32_16x16x32_bf16 v[108:111], v[244:247], a[56:59], v[108:111]
ds_read_b64_tr_b16 v[230:231], v51 offset:18432
v_mfma_f32_16x16x32_bf16 v[124:127], v[244:247], a[60:63], v[124:127]
s_waitcnt vmcnt(8) lgkmcnt(4)
v_mfma_f32_16x16x32_bf16 v[64:67], v[216:219], a[64:67], v[64:67]
ds_read_b64_tr_b16 v[232:233], v44 offset:49152
v_mfma_f32_16x16x32_bf16 v[80:83], v[216:219], a[68:71], v[80:83]
v_mfma_f32_16x16x32_bf16 v[96:99], v[216:219], a[72:75], v[96:99]
ds_read_b64_tr_b16 v[234:235], v44 offset:51200
v_mfma_f32_16x16x32_bf16 v[112:115], v[216:219], a[76:79], v[112:115]
v_mfma_f32_16x16x32_bf16 v[68:71], v[220:223], a[64:67], v[68:71]
ds_read_b64_tr_b16 v[236:237], v45 offset:49152
v_mfma_f32_16x16x32_bf16 v[84:87], v[220:223], a[68:71], v[84:87]
v_mfma_f32_16x16x32_bf16 v[100:103], v[220:223], a[72:75], v[100:103]
ds_read_b64_tr_b16 v[238:239], v45 offset:51200
v_mfma_f32_16x16x32_bf16 v[116:119], v[220:223], a[76:79], v[116:119]
s_waitcnt lgkmcnt(4)
v_mfma_f32_16x16x32_bf16 v[72:75], v[224:227], a[64:67], v[72:75]
ds_read_b64_tr_b16 v[240:241], v46 offset:49152
v_mfma_f32_16x16x32_bf16 v[88:91], v[224:227], a[68:71], v[88:91]
v_mfma_f32_16x16x32_bf16 v[104:107], v[224:227], a[72:75], v[104:107]
ds_read_b64_tr_b16 v[242:243], v46 offset:51200
v_mfma_f32_16x16x32_bf16 v[120:123], v[224:227], a[76:79], v[120:123]
v_mfma_f32_16x16x32_bf16 v[76:79], v[228:231], a[64:67], v[76:79]
ds_read_b64_tr_b16 v[244:245], v47 offset:49152
v_mfma_f32_16x16x32_bf16 v[92:95], v[228:231], a[68:71], v[92:95]
v_mfma_f32_16x16x32_bf16 v[108:111], v[228:231], a[72:75], v[108:111]
ds_read_b64_tr_b16 v[246:247], v47 offset:51200
v_mfma_f32_16x16x32_bf16 v[124:127], v[228:231], a[76:79], v[124:127]
s_waitcnt vmcnt(0) lgkmcnt(0)
s_barrier
v_mfma_f32_16x16x32_bf16 v[80:83], v[232:235], a[84:87], v[80:83]
v_mfma_f32_16x16x32_bf16 v[84:87], v[236:239], a[84:87], v[84:87]
v_mfma_f32_16x16x32_bf16 v[88:91], v[240:243], a[84:87], v[88:91]
v_mfma_f32_16x16x32_bf16 v[92:95], v[244:247], a[84:87], v[92:95]
v_mfma_f32_16x16x32_bf16 v[96:99], v[232:235], a[88:91], v[96:99]
v_mfma_f32_16x16x32_bf16 v[100:103], v[236:239], a[88:91], v[100:103]
v_mfma_f32_16x16x32_bf16 v[104:107], v[240:243], a[88:91], v[104:107]
v_mfma_f32_16x16x32_bf16 v[108:111], v[244:247], a[88:91], v[108:111]
v_mfma_f32_16x16x32_bf16 v[112:115], v[232:235], a[92:95], v[112:115]
ds_write_b128 v17, v[80:83] offset:0
v_mfma_f32_16x16x32_bf16 v[116:119], v[236:239], a[92:95], v[116:119]
ds_write_b128 v17, v[84:87] offset:1024
v_mfma_f32_16x16x32_bf16 v[120:123], v[240:243], a[92:95], v[120:123]
ds_write_b128 v17, v[88:91] offset:2048
v_mfma_f32_16x16x32_bf16 v[124:127], v[244:247], a[92:95], v[124:127]
ds_write_b128 v17, v[92:95] offset:3072
v_mfma_f32_16x16x32_bf16 v[64:67], v[232:235], a[80:83], v[64:67]
ds_write_b128 v18, v[96:99] offset:0
v_mfma_f32_16x16x32_bf16 v[68:71], v[236:239], a[80:83], v[68:71]
ds_write_b128 v18, v[100:103] offset:1024
v_mfma_f32_16x16x32_bf16 v[72:75], v[240:243], a[80:83], v[72:75]
ds_write_b128 v18, v[104:107] offset:2048
v_mfma_f32_16x16x32_bf16 v[76:79], v[244:247], a[80:83], v[76:79]
ds_write_b128 v18, v[108:111] offset:3072
ds_write_b128 v19, v[112:115] offset:0
ds_write_b128 v19, v[116:119] offset:1024
ds_write_b128 v19, v[120:123] offset:2048
ds_write_b128 v19, v[124:127] offset:3072
s_cmp_lg_u32 s39, 0
s_cbranch_scc1 Lout
s_waitcnt lgkmcnt(0)
s_add_u32 m0, s51, 0
s_add_u32 s40, s80, 0
buffer_load_dwordx4 v1, s[24:27], s40 offen offset:0 sc1 lds
s_barrier
ds_read_b128 v[128:131], v20 offset:0
ds_read_b128 v[132:135], v20 offset:1024
ds_read_b128 v[136:139], v20 offset:2048
buffer_load_dwordx4 v1, s[24:27], s40 offen offset:1024 sc1 lds
ds_read_b128 v[140:143], v20 offset:3072
ds_read_b128 v[144:147], v20 offset:4096
ds_read_b128 v[148:151], v20 offset:5120
ds_read_b128 v[152:155], v20 offset:6144
buffer_load_dwordx4 v1, s[24:27], s40 offen offset:2048 sc1 lds
ds_read_b128 v[156:159], v20 offset:7168
ds_read_b128 v[160:163], v20 offset:8192
ds_read_b128 v[164:167], v20 offset:9216
ds_read_b128 v[168:171], v20 offset:10240
buffer_load_dwordx4 v1, s[24:27], s40 offen offset:3072 sc1 lds
ds_read_b128 v[172:175], v20 offset:11264
s_waitcnt lgkmcnt(8)
v_pk_add_f32 v[64:65], v[64:65], v[128:129]
v_pk_add_f32 v[66:67], v[66:67], v[130:131]
v_pk_add_f32 v[68:69], v[68:69], v[132:133]
v_pk_add_f32 v[70:71], v[70:71], v[134:135]
v_pk_add_f32 v[72:73], v[72:73], v[136:137]
v_pk_add_f32 v[74:75], v[74:75], v[138:139]
v_pk_add_f32 v[76:77], v[76:77], v[140:141]
v_pk_add_f32 v[78:79], v[78:79], v[142:143]
s_waitcnt lgkmcnt(0)
v_pk_add_f32 v[144:145], v[144:145], v[160:161]
v_pk_add_f32 v[146:147], v[146:147], v[162:163]
v_pk_add_f32 v[148:149], v[148:149], v[164:165]
v_pk_add_f32 v[150:151], v[150:151], v[166:167]
v_pk_add_f32 v[152:153], v[152:153], v[168:169]
v_pk_add_f32 v[154:155], v[154:155], v[170:171]
v_pk_add_f32 v[156:157], v[156:157], v[172:173]
v_pk_add_f32 v[158:159], v[158:159], v[174:175]
v_pk_add_f32 v[128:129], v[64:65], v[144:145]
v_pk_add_f32 v[130:131], v[66:67], v[146:147]
v_pk_add_f32 v[132:133], v[68:69], v[148:149]
v_pk_add_f32 v[134:135], v[70:71], v[150:151]
v_pk_add_f32 v[136:137], v[72:73], v[152:153]
v_pk_add_f32 v[138:139], v[74:75], v[154:155]
v_pk_add_f32 v[140:141], v[76:77], v[156:157]
v_pk_add_f32 v[142:143], v[78:79], v[158:159]
v_lshlrev_b32 v96, 16, v2
v_and_b32 v97, 0xffff0000, v2
v_pk_add_f32 v[96:97], v[96:97], v[128:129]
v_cvt_pk_bf16_f32 v2, v96, v97
v_lshlrev_b32 v98, 16, v3
v_and_b32 v99, 0xffff0000, v3
v_pk_add_f32 v[98:99], v[98:99], v[130:131]
v_cvt_pk_bf16_f32 v3, v98, v99
v_lshlrev_b32 v100, 16, v4
v_and_b32 v101, 0xffff0000, v4
v_pk_add_f32 v[100:101], v[100:101], v[132:133]
v_cvt_pk_bf16_f32 v4, v100, v101
v_lshlrev_b32 v102, 16, v5
v_and_b32 v103, 0xffff0000, v5
v_pk_add_f32 v[102:103], v[102:103], v[134:135]
v_cvt_pk_bf16_f32 v5, v102, v103
v_lshlrev_b32 v104, 16, v6
v_and_b32 v105, 0xffff0000, v6
v_pk_add_f32 v[104:105], v[104:105], v[136:137]
v_cvt_pk_bf16_f32 v6, v104, v105
v_lshlrev_b32 v106, 16, v7
v_and_b32 v107, 0xffff0000, v7
v_pk_add_f32 v[106:107], v[106:107], v[138:139]
v_cvt_pk_bf16_f32 v7, v106, v107
v_lshlrev_b32 v108, 16, v8
v_and_b32 v109, 0xffff0000, v8
v_pk_add_f32 v[108:109], v[108:109], v[140:141]
v_cvt_pk_bf16_f32 v8, v108, v109
v_lshlrev_b32 v110, 16, v9
v_and_b32 v111, 0xffff0000, v9
v_pk_add_f32 v[110:111], v[110:111], v[142:143]
v_cvt_pk_bf16_f32 v9, v110, v111
s_lshl_b32 s58, s63, 11
s_add_u32 s58, s58, s42
s_add_u32 s58, s58, s60
s_add_u32 s53, s58, 29360128
buffer_store_dwordx4 v[2:5], v1, s[24:27], s53 offen offset:0 sc1
buffer_store_dwordx4 v[6:9], v1, s[24:27], s53 offen offset:1024 sc1
v_pk_mul_f32 v[20:21], v[96:97], v[96:97]
v_pk_fma_f32 v[20:21], v[98:99], v[98:99], v[20:21]
v_pk_add_f32 v[96:97], v[96:97], v[98:99]
v_pk_fma_f32 v[20:21], v[100:101], v[100:101], v[20:21]
v_pk_add_f32 v[96:97], v[96:97], v[100:101]
v_pk_fma_f32 v[20:21], v[102:103], v[102:103], v[20:21]
v_pk_add_f32 v[96:97], v[96:97], v[102:103]
v_pk_fma_f32 v[20:21], v[104:105], v[104:105], v[20:21]
v_pk_add_f32 v[96:97], v[96:97], v[104:105]
v_pk_fma_f32 v[20:21], v[106:107], v[106:107], v[20:21]
v_pk_add_f32 v[96:97], v[96:97], v[106:107]
v_pk_fma_f32 v[20:21], v[108:109], v[108:109], v[20:21]
v_pk_add_f32 v[96:97], v[96:97], v[108:109]
v_pk_fma_f32 v[20:21], v[110:111], v[110:111], v[20:21]
v_pk_add_f32 v[96:97], v[96:97], v[110:111]
v_add_f32 v21, v20, v21
v_add_f32 v20, v96, v97
v_mov_b32 v17, v20
s_nop 1
v_permlane16_swap_b32 v20, v17
v_add_f32 v20, v20, v17
v_mov_b32 v17, v20
s_nop 1
v_permlane32_swap_b32 v20, v17
v_add_f32 v20, v20, v17
v_mov_b32 v18, v21
s_nop 1
v_permlane16_swap_b32 v21, v18
v_add_f32 v21, v21, v18
v_mov_b32 v18, v21
s_nop 1
v_permlane32_swap_b32 v21, v18
v_add_f32 v21, v21, v18
s_lshr_b32 s58, s42, 4
s_lshl_b32 s57, s63, 7
s_add_u32 s58, s58, s57
s_add_u32 s58, s58, s60
s_add_u32 s54, s58, 31457280
v_lshlrev_b32 v17, 3, v0
s_mov_b64 exec, 0xffff
buffer_store_dwordx2 v[20:21], v17, s[24:27], s54 offen sc1
s_mov_b64 exec, -1
s_add_u32 m0, s51, 16384
s_add_u32 s40, s81, 0
buffer_load_dwordx4 v1, s[24:27], s40 offen offset:0 sc1 lds
buffer_load_dwordx4 v1, s[24:27], s40 offen offset:1024 sc1 lds
buffer_load_dwordx4 v1, s[24:27], s40 offen offset:2048 sc1 lds
buffer_load_dwordx4 v1, s[24:27], s40 offen offset:3072 sc1 lds
s_add_u32 m0, s51, 32768
s_add_u32 s40, s80, 32768
buffer_load_dwordx4 v1, s[24:27], s40 offen offset:0 sc1 lds
buffer_load_dwordx4 v1, s[24:27], s40 offen offset:1024 sc1 lds
buffer_load_dwordx4 v1, s[24:27], s40 offen offset:2048 sc1 lds
buffer_load_dwordx4 v1, s[24:27], s40 offen offset:3072 sc1 lds
s_add_u32 m0, s51, 49152
s_add_u32 s40, s81, 32768
buffer_load_dwordx4 v1, s[24:27], s40 offen offset:0 sc1 lds
buffer_load_dwordx4 v1, s[24:27], s40 offen offset:1024 sc1 lds
s_add_u32 s61, s61, 1
s_or_b32 s57, s44, s61
v_mov_b32 v22, s57
v_mov_b32 v23, s45
s_lshl_b32 s58, s37, 3
s_cmp_lg_u32 s38, 0
s_waitcnt vmcnt(10)
s_barrier
s_cbranch_scc1 Lsig3932
s_mov_b64 exec, 1
buffer_store_dwordx2 v[22:23], v12, s[24:27], s58 offen sc1
s_mov_b64 exec, -1
Lsig3932:
buffer_load_dwordx4 v1, s[24:27], s40 offen offset:2048 sc1 lds
buffer_load_dwordx4 v1, s[24:27], s40 offen offset:3072 sc1 lds
s_add_u32 m0, s51, 65536
s_add_u32 s40, s80, 65536
buffer_load_dwordx4 v1, s[24:27], s40 offen offset:0 sc1 lds
buffer_load_dwordx4 v1, s[24:27], s40 offen offset:1024 sc1 lds
buffer_load_dwordx4 v1, s[24:27], s40 offen offset:2048 sc1 lds
buffer_load_dwordx4 v1, s[24:27], s40 offen offset:3072 sc1 lds
s_add_u32 m0, s51, 81920
s_add_u32 s40, s81, 65536
buffer_load_dwordx4 v1, s[24:27], s40 offen offset:0 sc1 lds
buffer_load_dwordx4 v1, s[24:27], s40 offen offset:1024 sc1 lds
buffer_load_dwordx4 v1, s[24:27], s40 offen offset:2048 sc1 lds
buffer_load_dwordx4 v1, s[24:27], s40 offen offset:3072 sc1 lds
s_mov_b32 s39, 1
s_mov_b32 s60, 16777216
s_branch Llayer
Lout:
s_waitcnt lgkmcnt(0)
s_barrier
ds_read_b128 v[128:131], v20 offset:0
ds_read_b128 v[132:135], v20 offset:1024
ds_read_b128 v[136:139], v20 offset:2048
ds_read_b128 v[140:143], v20 offset:3072
ds_read_b128 v[144:147], v20 offset:4096
ds_read_b128 v[148:151], v20 offset:5120
ds_read_b128 v[152:155], v20 offset:6144
ds_read_b128 v[156:159], v20 offset:7168
ds_read_b128 v[160:163], v20 offset:8192
ds_read_b128 v[164:167], v20 offset:9216
ds_read_b128 v[168:171], v20 offset:10240
ds_read_b128 v[172:175], v20 offset:11264
s_waitcnt lgkmcnt(8)
v_pk_add_f32 v[64:65], v[64:65], v[128:129]
v_pk_add_f32 v[66:67], v[66:67], v[130:131]
v_pk_add_f32 v[68:69], v[68:69], v[132:133]
v_pk_add_f32 v[70:71], v[70:71], v[134:135]
v_pk_add_f32 v[72:73], v[72:73], v[136:137]
v_pk_add_f32 v[74:75], v[74:75], v[138:139]
v_pk_add_f32 v[76:77], v[76:77], v[140:141]
v_pk_add_f32 v[78:79], v[78:79], v[142:143]
s_waitcnt lgkmcnt(0)
v_pk_add_f32 v[144:145], v[144:145], v[160:161]
v_pk_add_f32 v[146:147], v[146:147], v[162:163]
v_pk_add_f32 v[148:149], v[148:149], v[164:165]
v_pk_add_f32 v[150:151], v[150:151], v[166:167]
v_pk_add_f32 v[152:153], v[152:153], v[168:169]
v_pk_add_f32 v[154:155], v[154:155], v[170:171]
v_pk_add_f32 v[156:157], v[156:157], v[172:173]
v_pk_add_f32 v[158:159], v[158:159], v[174:175]
v_pk_add_f32 v[128:129], v[64:65], v[144:145]
v_pk_add_f32 v[130:131], v[66:67], v[146:147]
v_pk_add_f32 v[132:133], v[68:69], v[148:149]
v_pk_add_f32 v[134:135], v[70:71], v[150:151]
v_pk_add_f32 v[136:137], v[72:73], v[152:153]
v_pk_add_f32 v[138:139], v[74:75], v[154:155]
v_pk_add_f32 v[140:141], v[76:77], v[156:157]
v_pk_add_f32 v[142:143], v[78:79], v[158:159]
v_lshlrev_b32 v96, 16, v2
v_and_b32 v97, 0xffff0000, v2
v_pk_add_f32 v[96:97], v[96:97], v[128:129]
v_cvt_pk_bf16_f32 v2, v96, v97
v_lshlrev_b32 v98, 16, v3
v_and_b32 v99, 0xffff0000, v3
v_pk_add_f32 v[98:99], v[98:99], v[130:131]
v_cvt_pk_bf16_f32 v3, v98, v99
v_lshlrev_b32 v100, 16, v4
v_and_b32 v101, 0xffff0000, v4
v_pk_add_f32 v[100:101], v[100:101], v[132:133]
v_cvt_pk_bf16_f32 v4, v100, v101
v_lshlrev_b32 v102, 16, v5
v_and_b32 v103, 0xffff0000, v5
v_pk_add_f32 v[102:103], v[102:103], v[134:135]
v_cvt_pk_bf16_f32 v5, v102, v103
v_lshlrev_b32 v104, 16, v6
v_and_b32 v105, 0xffff0000, v6
v_pk_add_f32 v[104:105], v[104:105], v[136:137]
v_cvt_pk_bf16_f32 v6, v104, v105
v_lshlrev_b32 v106, 16, v7
v_and_b32 v107, 0xffff0000, v7
v_pk_add_f32 v[106:107], v[106:107], v[138:139]
v_cvt_pk_bf16_f32 v7, v106, v107
v_lshlrev_b32 v108, 16, v8
v_and_b32 v109, 0xffff0000, v8
v_pk_add_f32 v[108:109], v[108:109], v[140:141]
v_cvt_pk_bf16_f32 v8, v108, v109
v_lshlrev_b32 v110, 16, v9
v_and_b32 v111, 0xffff0000, v9
v_pk_add_f32 v[110:111], v[110:111], v[142:143]
v_cvt_pk_bf16_f32 v9, v110, v111
v_permlane16_swap_b32 v2, v4
v_permlane16_swap_b32 v3, v5
v_permlane16_swap_b32 v6, v8
v_permlane16_swap_b32 v7, v9
buffer_store_dwordx4 v[2:5], v59, s[28:31], s52 offen offset:0
buffer_store_dwordx4 v[6:9], v59, s[28:31], s52 offen offset:64
Lfin:
s_waitcnt vmcnt(0)
Lend:
s_endpgm
.section .rodata,"a"
.p2align 6
.amdhsa_kernel interleave_layers__sliding_local_dilated__dense_activation_silu__prompt_kernel
  .amdhsa_next_free_vgpr 512
  .amdhsa_next_free_sgpr 102
  .amdhsa_accum_offset 256
  .amdhsa_group_segment_fixed_size 0
  .amdhsa_kernarg_size 72
  .amdhsa_user_sgpr_count 2
  .amdhsa_user_sgpr_kernarg_segment_ptr 1
  .amdhsa_system_sgpr_workgroup_id_x 1
.end_amdhsa_kernel
```
